```python
import torch

def _softmax(x, axis=-1):
    return torch.softmax(x, dim=axis)
def _gelu(x):
    return torch.nn.functional.gelu(x, approximate="tanh")
def _silu(x):
    return torch.nn.functional.silu(x)
def _sigmoid(x):
    return torch.sigmoid(x)
def _layernorm(x, axis=-1, eps=1e-5):
    m = x.mean(dim=axis, keepdim=True)
    v = x.var(dim=axis, keepdim=True, unbiased=False)
    return (x - m) / torch.sqrt(v + eps)
def _scatter_add(tgt, idx, src, axis=0):
    return tgt.clone().index_add_(axis, idx, src)
def _segment_sum(src, seg, n):
    out = torch.zeros((n,) + src.shape[1:], dtype=src.dtype)
    return out.index_add_(0, seg, src)
def _pad(x, pw):
    flat = tuple(v for pair in reversed(pw) for v in pair)
    return torch.nn.functional.pad(x, flat)

kernel_name = 'gated_mix__mha_block_cached__glu_gated_swiglu__decode'

def setup_inputs():

    _w = (lambda a: (lambda t: t.to(torch.bfloat16) if t.is_floating_point() else t)(torch.as_tensor(a)))
    def _A_setup():
        B, Sq, D = 1, 1, 512
        H, Sk, Dh = 32, 32768, 128
        return {
            "x": _w((lambda *s: torch.randn(*s, dtype=torch.bfloat16) * 0.05)(B, Sq, D)),
            "k_cache": _w((lambda *s: torch.randn(*s, dtype=torch.bfloat16) * 6.4)(B, H, Sk, Dh)),
            "v_cache": _w((lambda *s: torch.randn(*s, dtype=torch.bfloat16) * 0.2)(B, H, Sk, Dh)),
            "wq": _w((lambda *s: torch.randn(*s, dtype=torch.bfloat16) * 6.4)(D, H * Dh) * (D ** -0.5)),
            "wo": _w((lambda *s: torch.randn(*s, dtype=torch.bfloat16) * 0.2)(H * Dh, D) * ((H * Dh) ** -0.5)),
        }
    _A_in = _A_setup()

    def _B_setup():
        B, S, D, F = 1, 1, 512, 1792
        return {
            "x": _w((lambda *s: torch.randn(*s, dtype=torch.bfloat16) * 0.05)(B, S, D)),
            "w1": _w((lambda *s: torch.randn(*s, dtype=torch.bfloat16) * 0.8)(D, F) * (2.0 / D) ** 0.5),
            "w3": _w((lambda *s: torch.randn(*s, dtype=torch.bfloat16) * 0.8)(D, F) * (2.0 / D) ** 0.5),
            "w2": _w((lambda *s: torch.randn(*s, dtype=torch.bfloat16) * 0.8)(F, D) * (2.0 / F) ** 0.5),
        }
    _B_in = _B_setup()

    return {
        "A_x": _A_in["x"],
        "A_k_cache": _A_in["k_cache"],
        "A_v_cache": _A_in["v_cache"],
        "A_wq": _A_in["wq"],
        "A_wo": _A_in["wo"],
        "B_x": _B_in["x"],
        "B_w1": _B_in["w1"],
        "B_w3": _B_in["w3"],
        "B_w2": _B_in["w2"],
        "gate_w": _w((lambda *s: torch.randn(*s, dtype=torch.bfloat16) * 0.05)(512) * 16.0),
    }

def reference(A_x, A_k_cache, A_v_cache, A_wq, A_wo, B_x, B_w1, B_w3, B_w2, gate_w):
    def _A_ref(x, k_cache, v_cache, wq, wo):
        B, Sq, D = x.shape
        H, Dh = 32, 128
        q = (lambda x, *d: x.permute(*d))((x @ wq).reshape(B, Sq, H, Dh), 0, 2, 1, 3)
        scores = torch.einsum("bhqd,bhkd->bhqk", q, k_cache) * (Dh ** -0.5)
        p = _softmax(scores, axis=-1)
        o = torch.einsum("bhqk,bhkd->bhqd", p, v_cache)
        return (lambda x, *d: x.permute(*d))(o, 0, 2, 1, 3).reshape(B, Sq, H * Dh) @ wo

    def _B_ref(x, w1, w3, w2):
        gate = torch.einsum("bsd,df->bsf", x, w1)
        up = torch.einsum("bsd,df->bsf", x, w3)
        h = _silu(gate) * up
        out = torch.einsum("bsf,fd->bsd", h, w2)
        return out

    x = A_x
    g = _sigmoid((x * gate_w).sum(-1, keepdims=True))
    a = _A_ref(x, A_k_cache, A_v_cache, A_wq, A_wo)
    b = _B_ref(x, B_w1, B_w3, B_w2)
    return g * a + (1 - g) * b
```

```asm
; @launch grid=(256,1,1) block=(448,1,1) lds=149712
.amdgcn_target "amdgcn-amd-amdhsa--gfx950"
.text
.globl gated_mix__mha_block_cached__glu_gated_swiglu__decode_kernel
.p2align 8
.type gated_mix__mha_block_cached__glu_gated_swiglu__decode_kernel,@function
gated_mix__mha_block_cached__glu_gated_swiglu__decode_kernel:
    s_load_dwordx16 s[8:23], s[0:1], 0
    s_load_dwordx8 s[24:31], s[0:1], 64
    s_load_dwordx2 s[32:33], s[0:1], 96
    s_cmp_ge_u32 s2, 256
    s_cbranch_scc1 L_end
    v_lshrrev_b32 v1, 6, v0
    v_and_b32 v0, 63, v0
    v_readfirstlane_b32 s3, v1
    s_and_b32 s5, s2, 7
    s_lshr_b32 s4, s2, 3
    s_mov_b32 s96, 4194304
    s_cmp_lg_u32 s3, 0
    s_cbranch_scc1 L_notloader
    s_setprio 3
    v_and_b32 v1, 15, v0
    v_lshlrev_b32 v1, 4, v1
    v_bfe_u32 v6, v0, 4, 1
    v_lshl_add_u32 v1, v6, 13, v1
    v_lshrrev_b32 v6, 5, v0
    v_lshl_add_u32 v1, v6, 9, v1
    v_and_b32 v6, 0x30, v0
    v_xor_b32 v2, v1, v6
    v_xor_b32 v3, 64, v2
    v_xor_b32 v4, 128, v2
    v_xor_b32 v5, 192, v2
    v_mov_b32 v7, 131072
    v_mov_b32 v8, 0
    v_mov_b32 v9, 0
    v_mov_b32 v10, 0
    v_mov_b32 v11, 0
    v_mov_b32 v12, 0
    v_mov_b32 v13, -1
    ds_write_b128 v7, v[8:11] offset:16
    ds_write_b64 v7, v[12:13]
    ds_write_b64 v7, v[8:9] offset:8
    s_lshl_b32 s35, s4, 23
    s_mov_b32 m0, 0
    v_mov_b32 v6, 0
    s_mov_b32 s45, 0
    s_bitcmp1_b32 s4, 0
    s_cselect_b32 s50, 137216, 0
    s_xor_b32 s45, s45, s50
    s_bitcmp1_b32 s4, 1
    s_cselect_b32 s50, 3195904, 0
    s_xor_b32 s45, s45, s50
    s_bitcmp1_b32 s4, 2
    s_cselect_b32 s50, 590080, 0
    s_xor_b32 s45, s45, s50
    s_bitcmp1_b32 s4, 3
    s_cselect_b32 s50, 19456, 0
    s_xor_b32 s45, s45, s50
    s_bitcmp1_b32 s4, 4
    s_cselect_b32 s50, 589824, 0
    s_xor_b32 s45, s45, s50
    s_mov_b32 s44, s45
    s_bitcmp1_b32 s5, 0
    s_cselect_b32 s50, 1199104, 0
    s_xor_b32 s44, s44, s50
    s_bitcmp1_b32 s5, 1
    s_cselect_b32 s50, 790528, 0
    s_xor_b32 s44, s44, s50
    s_bitcmp1_b32 s5, 2
    s_cselect_b32 s50, 49152, 0
    s_xor_b32 s44, s44, s50
    s_mov_b32 s38, 8388608
    s_mov_b32 s39, 0x20000
    s_mov_b32 s62, s44
    s_waitcnt lgkmcnt(0)
    s_add_u32 s36, s10, s35
    s_addc_u32 s37, s11, 0
    s_and_b32 s37, s37, 0xffff
    buffer_load_dwordx4 v2, s[36:39], s44 offen nt lds
    s_add_u32 m0, m0, 1024
    s_xor_b32 s51, s44, 1024
    buffer_load_dwordx4 v3, s[36:39], s51 offen nt lds
    s_add_u32 m0, m0, 1024
    s_xor_b32 s51, s44, 256
    buffer_load_dwordx4 v4, s[36:39], s51 offen nt lds
    s_add_u32 m0, m0, 1024
    s_xor_b32 s51, s44, 1280
    buffer_load_dwordx4 v5, s[36:39], s51 offen nt lds
    s_add_u32 m0, m0, 1024
    s_xor_b32 s51, s44, 65536
    buffer_load_dwordx4 v2, s[36:39], s51 offen nt lds
    s_add_u32 m0, m0, 1024
    s_xor_b32 s51, s44, 66560
    buffer_load_dwordx4 v3, s[36:39], s51 offen nt lds
    s_barrier
    s_add_u32 m0, m0, 1024
    s_xor_b32 s51, s44, 65792
    buffer_load_dwordx4 v4, s[36:39], s51 offen nt lds
    s_add_u32 m0, m0, 1024
    s_xor_b32 s51, s44, 66816
    buffer_load_dwordx4 v5, s[36:39], s51 offen nt lds
    s_add_u32 m0, m0, 1024
    s_xor_b32 s51, s44, 2048
    buffer_load_dwordx4 v2, s[36:39], s51 offen nt lds
    s_add_u32 m0, m0, 1024
    s_xor_b32 s51, s44, 3072
    buffer_load_dwordx4 v3, s[36:39], s51 offen nt lds
    s_add_u32 m0, m0, 1024
    s_xor_b32 s51, s44, 2304
    buffer_load_dwordx4 v4, s[36:39], s51 offen nt lds
    s_add_u32 m0, m0, 1024
    s_xor_b32 s51, s44, 3328
    buffer_load_dwordx4 v5, s[36:39], s51 offen nt lds
    s_add_u32 m0, m0, 1024
    s_xor_b32 s51, s44, 67584
    buffer_load_dwordx4 v2, s[36:39], s51 offen nt lds
    s_add_u32 m0, m0, 1024
    s_xor_b32 s51, s44, 68608
    buffer_load_dwordx4 v3, s[36:39], s51 offen nt lds
    s_add_u32 m0, m0, 1024
    s_xor_b32 s51, s44, 67840
    buffer_load_dwordx4 v4, s[36:39], s51 offen nt lds
    s_add_u32 m0, m0, 1024
    s_xor_b32 s51, s44, 68864
    buffer_load_dwordx4 v5, s[36:39], s51 offen nt lds
    s_add_u32 m0, m0, 1024
    s_xor_b32 s44, s44, 16384
    buffer_load_dwordx4 v2, s[36:39], s44 offen nt lds
    s_add_u32 m0, m0, 1024
    s_xor_b32 s51, s44, 1024
    buffer_load_dwordx4 v3, s[36:39], s51 offen nt lds
    s_add_u32 m0, m0, 1024
    s_xor_b32 s51, s44, 256
    buffer_load_dwordx4 v4, s[36:39], s51 offen nt lds
    s_add_u32 m0, m0, 1024
    s_xor_b32 s51, s44, 1280
    buffer_load_dwordx4 v5, s[36:39], s51 offen nt lds
    s_add_u32 m0, m0, 1024
    s_xor_b32 s51, s44, 65536
    buffer_load_dwordx4 v2, s[36:39], s51 offen nt lds
    v_mov_b32 v15, 0
    v_mov_b32 v14, 0
    s_mov_b32 s55, s35
    s_mov_b32 s35, 790528
    v_writelane_b32 v15, s35, 16
    s_mov_b32 s35, 792576
    v_writelane_b32 v15, s35, 17
    s_mov_b32 s35, 841728
    v_writelane_b32 v15, s35, 18
    s_mov_b32 s35, 825344
    v_writelane_b32 v15, s35, 19
    s_mov_b32 s35, 2020352
    v_writelane_b32 v15, s35, 20
    v_writelane_b32 v14, 0, 0
    v_writelane_b32 v14, 5, 1
    v_writelane_b32 v14, 9, 2
    v_writelane_b32 v14, 13, 3
    v_writelane_b32 v14, 16, 4
    v_writelane_b32 v14, 19, 5
    v_writelane_b32 v14, 21, 6
    v_writelane_b32 v14, 23, 7
    v_writelane_b32 v14, 25, 8
    v_writelane_b32 v14, 26, 9
    v_writelane_b32 v14, 27, 10
    v_writelane_b32 v14, 28, 11
    v_writelane_b32 v14, 29, 12
    v_writelane_b32 v14, 30, 13
    v_writelane_b32 v14, 31, 14
    v_writelane_b32 v14, 32, 15
    s_xor_b32 s35, s45, 7208960
    v_mov_b32 v16, s35
    v_bfe_i32 v8, v14, 0, 1
    v_and_b32 v8, 790528, v8
    v_xor_b32 v16, v16, v8
    v_bfe_i32 v8, v14, 1, 1
    v_and_b32 v8, 2048, v8
    v_xor_b32 v16, v16, v8
    v_bfe_i32 v8, v14, 2, 1
    v_and_b32 v8, 49152, v8
    v_xor_b32 v16, v16, v8
    v_bfe_i32 v8, v14, 3, 1
    v_and_b32 v8, 16384, v8
    v_xor_b32 v16, v16, v8
    v_bfe_i32 v8, v14, 4, 1
    v_and_b32 v8, 1199104, v8
    v_xor_b32 v16, v16, v8
    v_lshrrev_b32 v8, 3, v0
    v_and_b32 v9, 7, v0
    v_lshlrev_b32 v9, 4, v9
    v_lshl_add_u32 v23, v8, 12, v9
    v_mul_u32_u24 v24, 7168, v8
    v_add_u32 v24, v24, v9
    v_lshlrev_b32 v25, 12, v0
    s_lshl_b32 s52, s4, 17
    s_lshl_b32 s35, s5, 7
    s_add_u32 s52, s52, s35
    s_mul_i32 s53, s4, 57344
    s_add_u32 s53, s53, s35
    s_lshl_b32 s54, s5, 15
    s_lshl_b32 s35, s4, 7
    s_add_u32 s54, s54, s35
    s_add_u32 s54, s54, 1048576
    s_lshl_b32 s56, s4, 8
    s_add_u32 s56, s56, 16384
    s_mov_b32 s35, s55
    s_mov_b32 s46, 0
    s_mov_b32 s47, 4
    s_mov_b32 s58, 1
    s_mov_b32 s57, 0
    s_mov_b32 s49, 0
    v_mov_b32 v26, 0
    s_mov_b64 s[64:65], s[36:37]
    s_mov_b32 s66, 8388608
    s_mov_b32 s67, 0x20000
    s_add_u32 s40, s12, s35
    s_addc_u32 s41, s13, 0
    s_and_b32 s41, s41, 0xffff
    s_mov_b32 s42, 8388608
    s_mov_b32 s43, 0x20000
    v_mov_b32 v18, v2
    v_mov_b32 v19, v3
    v_mov_b32 v20, v4
    v_mov_b32 v21, v5
    s_mov_b32 s35, 16384
    v_writelane_b32 v15, s35, 0
    s_mov_b32 s35, 2113536
    v_writelane_b32 v15, s35, 1
    s_mov_b32 s35, 2637824
    v_writelane_b32 v15, s35, 2
    s_mov_b32 s35, 6832128
    v_writelane_b32 v15, s35, 3
    s_mov_b32 s35, 6963200
    v_writelane_b32 v15, s35, 4
    s_mov_b32 s35, 7225344
    v_writelane_b32 v15, s35, 5
    s_mov_b32 s68, s16
    s_and_b32 s69, s17, 0xffff
    s_mov_b32 s70, 4194304
    s_mov_b32 s71, 0x20000
    s_mov_b32 s72, s24
    s_and_b32 s73, s25, 0xffff
    s_mov_b32 s74, 1835008
    s_mov_b32 s75, 0x20000
    s_mov_b32 s76, s32
    s_and_b32 s77, s33, 0xffff
    s_mov_b32 s78, 2097152
    s_mov_b32 s79, 0x20000
    s_branch L_ld_enter
L_ld_unit:
    s_add_u32 m0, m0, 1024
    s_and_b32 m0, m0, 131071
    s_add_u32 s58, s58, 1
    s_ff1_i32_b32 s50, s58
    v_readlane_b32 s50, v15, s50
    s_nop 0
    s_xor_b32 s44, s44, s50
    s_cmp_lt_u32 s58, 62
    s_cbranch_scc0 L_ld_phase
L_ld_same:
    s_lshr_b32 s48, s47, 2
    s_sub_u32 s48, s48, 7
    s_cmp_ge_i32 s46, s48
    s_cbranch_scc1 L_ld_credit_ok
L_ld_credit:
    ds_read_b128 v[8:11], v7 offset:16
    s_sub_u32 s96, s96, 1
    s_cbranch_scc1 L_end
    s_waitcnt lgkmcnt(0)
    v_min3_u32 v8, v8, v9, v10
    v_min_u32 v8, v8, v11
    s_nop 0
    v_readfirstlane_b32 s46, v8
    s_nop 0
    s_cmp_lt_i32 s46, s48
    s_cbranch_scc1 L_ld_credit
L_ld_credit_ok:
    s_waitcnt lgkmcnt(0)
    v_readfirstlane_b32 s35, v26
    ds_read_b32 v26, v7 offset:12
    s_cmp_lg_u32 s47, 492
    s_cbranch_scc1 L_ld_noask
    s_mov_b32 s49, 1
    s_atomic_add s49, s[32:33], s56 glc
L_ld_noask:
    s_cmp_lg_u32 s35, 0
    s_cbranch_scc1 L_ld_b1
    s_waitcnt vmcnt(20)
    buffer_load_dwordx4 v2, s[36:39], s44 offen nt lds
    s_add_i32 s48, s47, -5
    v_max_i32 v6, s48, v6
    ds_write_b32 v7, v6
    s_add_u32 m0, m0, 1024
    s_xor_b32 s51, s44, 1024
    s_waitcnt vmcnt(20)
    buffer_load_dwordx4 v3, s[36:39], s51 offen nt lds
    s_add_u32 m0, m0, 1024
    s_xor_b32 s51, s44, 256
    s_waitcnt vmcnt(20)
    buffer_load_dwordx4 v4, s[36:39], s51 offen nt lds
    s_add_u32 m0, m0, 1024
    s_xor_b32 s51, s44, 1280
    s_waitcnt vmcnt(20)
    buffer_load_dwordx4 v5, s[36:39], s51 offen nt lds
    s_add_u32 m0, m0, 1024
    s_xor_b32 s51, s44, 65536
    s_waitcnt vmcnt(20)
    buffer_load_dwordx4 v2, s[36:39], s51 offen nt lds
    s_add_i32 s48, s47, -4
    v_max_i32 v6, s48, v6
    ds_write_b32 v7, v6
L_ld_enter:
    s_add_u32 m0, m0, 1024
    s_xor_b32 s51, s44, 66560
    s_waitcnt vmcnt(20)
    buffer_load_dwordx4 v3, s[36:39], s51 offen nt lds
    s_add_u32 m0, m0, 1024
    s_xor_b32 s51, s44, 65792
    s_waitcnt vmcnt(20)
    buffer_load_dwordx4 v4, s[36:39], s51 offen nt lds
    s_add_u32 m0, m0, 1024
    s_xor_b32 s51, s44, 66816
    s_waitcnt vmcnt(20)
    buffer_load_dwordx4 v5, s[36:39], s51 offen nt lds
    s_add_u32 m0, m0, 1024
    s_xor_b32 s51, s44, 2048
    s_waitcnt vmcnt(20)
    buffer_load_dwordx4 v2, s[36:39], s51 offen nt lds
    s_add_i32 s48, s47, -3
    v_max_i32 v6, s48, v6
    ds_write_b32 v7, v6
    s_add_u32 m0, m0, 1024
    s_xor_b32 s51, s44, 3072
    s_waitcnt vmcnt(20)
    buffer_load_dwordx4 v3, s[36:39], s51 offen nt lds
    s_add_u32 m0, m0, 1024
    s_xor_b32 s51, s44, 2304
    s_waitcnt vmcnt(20)
    buffer_load_dwordx4 v4, s[36:39], s51 offen nt lds
    s_add_u32 m0, m0, 1024
    s_xor_b32 s51, s44, 3328
    s_waitcnt vmcnt(20)
    buffer_load_dwordx4 v5, s[36:39], s51 offen nt lds
    s_add_u32 m0, m0, 1024
    s_xor_b32 s51, s44, 67584
    s_waitcnt vmcnt(20)
    buffer_load_dwordx4 v2, s[36:39], s51 offen nt lds
    s_add_i32 s48, s47, -2
    v_max_i32 v6, s48, v6
    ds_write_b32 v7, v6
    s_add_u32 m0, m0, 1024
    s_xor_b32 s51, s44, 68608
    s_waitcnt vmcnt(20)
    buffer_load_dwordx4 v3, s[36:39], s51 offen nt lds
    s_add_u32 m0, m0, 1024
    s_xor_b32 s51, s44, 67840
    s_waitcnt vmcnt(20)
    buffer_load_dwordx4 v4, s[36:39], s51 offen nt lds
    s_add_u32 m0, m0, 1024
    s_xor_b32 s51, s44, 68864
    s_waitcnt vmcnt(20)
    buffer_load_dwordx4 v5, s[36:39], s51 offen nt lds
    s_add_u32 s47, s47, 4
    s_branch L_ld_unit
L_ld_b1:
    s_cmp_lg_u32 s35, 1
    s_cbranch_scc1 L_ld_b2
    s_waitcnt vmcnt(17)
    buffer_load_dwordx4 v2, s[36:39], s44 offen nt lds
    s_add_u32 m0, m0, 1024
    s_xor_b32 s51, s44, 1024
    s_waitcnt vmcnt(17)
    buffer_load_dwordx4 v3, s[36:39], s51 offen nt lds
    s_add_i32 s48, s47, -4
    v_max_i32 v6, s48, v6
    ds_write_b32 v7, v6
    s_add_u32 m0, m0, 1024
    s_xor_b32 s51, s44, 256
    s_waitcnt vmcnt(17)
    buffer_load_dwordx4 v4, s[36:39], s51 offen nt lds
    s_add_u32 m0, m0, 1024
    s_xor_b32 s51, s44, 1280
    s_waitcnt vmcnt(17)
    buffer_load_dwordx4 v5, s[36:39], s51 offen nt lds
    s_add_u32 m0, m0, 1024
    s_xor_b32 s51, s44, 65536
    s_waitcnt vmcnt(17)
    buffer_load_dwordx4 v2, s[36:39], s51 offen nt lds
    s_add_u32 m0, m0, 1024
    s_xor_b32 s51, s44, 66560
    s_waitcnt vmcnt(17)
    buffer_load_dwordx4 v3, s[36:39], s51 offen nt lds
    s_add_i32 s48, s47, -3
    v_max_i32 v6, s48, v6
    ds_write_b32 v7, v6
    s_add_u32 m0, m0, 1024
    s_xor_b32 s51, s44, 65792
    s_waitcnt vmcnt(17)
    buffer_load_dwordx4 v4, s[36:39], s51 offen nt lds
    s_add_u32 m0, m0, 1024
    s_xor_b32 s51, s44, 66816
    s_waitcnt vmcnt(17)
    buffer_load_dwordx4 v5, s[36:39], s51 offen nt lds
    s_add_u32 m0, m0, 1024
    s_xor_b32 s51, s44, 2048
    s_waitcnt vmcnt(17)
    buffer_load_dwordx4 v2, s[36:39], s51 offen nt lds
    s_add_u32 m0, m0, 1024
    s_xor_b32 s51, s44, 3072
    s_waitcnt vmcnt(17)
    buffer_load_dwordx4 v3, s[36:39], s51 offen nt lds
    s_add_i32 s48, s47, -2
    v_max_i32 v6, s48, v6
    ds_write_b32 v7, v6
    s_add_u32 m0, m0, 1024
    s_xor_b32 s51, s44, 2304
    s_waitcnt vmcnt(17)
    buffer_load_dwordx4 v4, s[36:39], s51 offen nt lds
    s_add_u32 m0, m0, 1024
    s_xor_b32 s51, s44, 3328
    s_waitcnt vmcnt(17)
    buffer_load_dwordx4 v5, s[36:39], s51 offen nt lds
    s_add_u32 m0, m0, 1024
    s_xor_b32 s51, s44, 67584
    s_waitcnt vmcnt(17)
    buffer_load_dwordx4 v2, s[36:39], s51 offen nt lds
    s_add_u32 m0, m0, 1024
    s_xor_b32 s51, s44, 68608
    s_waitcnt vmcnt(17)
    buffer_load_dwordx4 v3, s[36:39], s51 offen nt lds
    s_add_i32 s48, s47, -1
    v_max_i32 v6, s48, v6
    ds_write_b32 v7, v6
    s_add_u32 m0, m0, 1024
    s_xor_b32 s51, s44, 67840
    s_waitcnt vmcnt(17)
    buffer_load_dwordx4 v4, s[36:39], s51 offen nt lds
    s_add_u32 m0, m0, 1024
    s_xor_b32 s51, s44, 68864
    s_waitcnt vmcnt(17)
    buffer_load_dwordx4 v5, s[36:39], s51 offen nt lds
    s_add_u32 s47, s47, 4
    s_branch L_ld_unit
L_ld_b2:
    s_cmp_lg_u32 s35, 2
    s_cbranch_scc1 L_ld_b3
    s_waitcnt vmcnt(23)
    buffer_load_dwordx4 v2, s[36:39], s44 offen nt lds
    s_add_u32 m0, m0, 1024
    s_xor_b32 s51, s44, 1024
    s_waitcnt vmcnt(23)
    buffer_load_dwordx4 v3, s[36:39], s51 offen nt lds
    s_add_u32 m0, m0, 1024
    s_xor_b32 s51, s44, 256
    s_waitcnt vmcnt(23)
    buffer_load_dwordx4 v4, s[36:39], s51 offen nt lds
    s_add_u32 m0, m0, 1024
    s_xor_b32 s51, s44, 1280
    s_waitcnt vmcnt(23)
    buffer_load_dwordx4 v5, s[36:39], s51 offen nt lds
    s_add_i32 s48, s47, -5
    v_max_i32 v6, s48, v6
    ds_write_b32 v7, v6
    s_add_u32 m0, m0, 1024
    s_xor_b32 s51, s44, 65536
    s_waitcnt vmcnt(23)
    buffer_load_dwordx4 v2, s[36:39], s51 offen nt lds
    s_add_u32 m0, m0, 1024
    s_xor_b32 s51, s44, 66560
    s_waitcnt vmcnt(23)
    buffer_load_dwordx4 v3, s[36:39], s51 offen nt lds
    s_add_u32 m0, m0, 1024
    s_xor_b32 s51, s44, 65792
    s_waitcnt vmcnt(23)
    buffer_load_dwordx4 v4, s[36:39], s51 offen nt lds
    s_add_u32 m0, m0, 1024
    s_xor_b32 s51, s44, 66816
    s_waitcnt vmcnt(23)
    buffer_load_dwordx4 v5, s[36:39], s51 offen nt lds
    s_add_i32 s48, s47, -4
    v_max_i32 v6, s48, v6
    ds_write_b32 v7, v6
    s_add_u32 m0, m0, 1024
    s_xor_b32 s51, s44, 2048
    s_waitcnt vmcnt(23)
    buffer_load_dwordx4 v2, s[36:39], s51 offen nt lds
    s_add_u32 m0, m0, 1024
    s_xor_b32 s51, s44, 3072
    s_waitcnt vmcnt(23)
    buffer_load_dwordx4 v3, s[36:39], s51 offen nt lds
    s_add_u32 m0, m0, 1024
    s_xor_b32 s51, s44, 2304
    s_waitcnt vmcnt(23)
    buffer_load_dwordx4 v4, s[36:39], s51 offen nt lds
    s_add_u32 m0, m0, 1024
    s_xor_b32 s51, s44, 3328
    s_waitcnt vmcnt(23)
    buffer_load_dwordx4 v5, s[36:39], s51 offen nt lds
    s_add_i32 s48, s47, -3
    v_max_i32 v6, s48, v6
    ds_write_b32 v7, v6
    s_add_u32 m0, m0, 1024
    s_xor_b32 s51, s44, 67584
    s_waitcnt vmcnt(23)
    buffer_load_dwordx4 v2, s[36:39], s51 offen nt lds
    s_add_u32 m0, m0, 1024
    s_xor_b32 s51, s44, 68608
    s_waitcnt vmcnt(23)
    buffer_load_dwordx4 v3, s[36:39], s51 offen nt lds
    s_add_u32 m0, m0, 1024
    s_xor_b32 s51, s44, 67840
    s_waitcnt vmcnt(23)
    buffer_load_dwordx4 v4, s[36:39], s51 offen nt lds
    s_add_u32 m0, m0, 1024
    s_xor_b32 s51, s44, 68864
    s_waitcnt vmcnt(23)
    buffer_load_dwordx4 v5, s[36:39], s51 offen nt lds
    s_add_i32 s48, s47, -2
    v_max_i32 v6, s48, v6
    ds_write_b32 v7, v6
    s_add_u32 s47, s47, 4
    s_branch L_ld_unit
L_ld_b3:
    s_cmp_lg_u32 s35, 3
    s_cbranch_scc1 L_ld_b4
    s_waitcnt vmcnt(29)
    buffer_load_dwordx4 v2, s[36:39], s44 offen nt lds
    s_add_u32 m0, m0, 1024
    s_xor_b32 s51, s44, 1024
    s_waitcnt vmcnt(29)
    buffer_load_dwordx4 v3, s[36:39], s51 offen nt lds
    s_add_i32 s48, s47, -7
    v_max_i32 v6, s48, v6
    ds_write_b32 v7, v6
    s_add_u32 m0, m0, 1024
    s_xor_b32 s51, s44, 256
    s_waitcnt vmcnt(29)
    buffer_load_dwordx4 v4, s[36:39], s51 offen nt lds
    s_add_u32 m0, m0, 1024
    s_xor_b32 s51, s44, 1280
    s_waitcnt vmcnt(29)
    buffer_load_dwordx4 v5, s[36:39], s51 offen nt lds
    s_add_u32 m0, m0, 1024
    s_xor_b32 s51, s44, 65536
    s_waitcnt vmcnt(29)
    buffer_load_dwordx4 v2, s[36:39], s51 offen nt lds
    s_add_u32 m0, m0, 1024
    s_xor_b32 s51, s44, 66560
    s_waitcnt vmcnt(29)
    buffer_load_dwordx4 v3, s[36:39], s51 offen nt lds
    s_add_i32 s48, s47, -6
    v_max_i32 v6, s48, v6
    ds_write_b32 v7, v6
    s_add_u32 m0, m0, 1024
    s_xor_b32 s51, s44, 65792
    s_waitcnt vmcnt(29)
    buffer_load_dwordx4 v4, s[36:39], s51 offen nt lds
    s_add_u32 m0, m0, 1024
    s_xor_b32 s51, s44, 66816
    s_waitcnt vmcnt(29)
    buffer_load_dwordx4 v5, s[36:39], s51 offen nt lds
    s_add_u32 m0, m0, 1024
    s_xor_b32 s51, s44, 2048
    s_waitcnt vmcnt(29)
    buffer_load_dwordx4 v2, s[36:39], s51 offen nt lds
    s_add_u32 m0, m0, 1024
    s_xor_b32 s51, s44, 3072
    s_waitcnt vmcnt(29)
    buffer_load_dwordx4 v3, s[36:39], s51 offen nt lds
    s_add_i32 s48, s47, -5
    v_max_i32 v6, s48, v6
    ds_write_b32 v7, v6
    s_add_u32 m0, m0, 1024
    s_xor_b32 s51, s44, 2304
    s_waitcnt vmcnt(29)
    buffer_load_dwordx4 v4, s[36:39], s51 offen nt lds
    s_add_u32 m0, m0, 1024
    s_xor_b32 s51, s44, 3328
    s_waitcnt vmcnt(29)
    buffer_load_dwordx4 v5, s[36:39], s51 offen nt lds
    s_add_u32 m0, m0, 1024
    s_xor_b32 s51, s44, 67584
    s_waitcnt vmcnt(29)
    buffer_load_dwordx4 v2, s[36:39], s51 offen nt lds
    s_add_u32 m0, m0, 1024
    s_xor_b32 s51, s44, 68608
    s_waitcnt vmcnt(29)
    buffer_load_dwordx4 v3, s[36:39], s51 offen nt lds
    s_add_i32 s48, s47, -4
    v_max_i32 v6, s48, v6
    ds_write_b32 v7, v6
    s_add_u32 m0, m0, 1024
    s_xor_b32 s51, s44, 67840
    s_waitcnt vmcnt(29)
    buffer_load_dwordx4 v4, s[36:39], s51 offen nt lds
    s_add_u32 m0, m0, 1024
    s_xor_b32 s51, s44, 68864
    s_waitcnt vmcnt(29)
    buffer_load_dwordx4 v5, s[36:39], s51 offen nt lds
    s_add_u32 s47, s47, 4
    s_branch L_ld_unit
L_ld_b4:
    s_waitcnt vmcnt(37)
    buffer_load_dwordx4 v2, s[36:39], s44 offen nt lds
    s_add_u32 m0, m0, 1024
    s_xor_b32 s51, s44, 1024
    s_waitcnt vmcnt(37)
    buffer_load_dwordx4 v3, s[36:39], s51 offen nt lds
    s_add_i32 s48, s47, -9
    v_max_i32 v6, s48, v6
    ds_write_b32 v7, v6
    s_add_u32 m0, m0, 1024
    s_xor_b32 s51, s44, 256
    s_waitcnt vmcnt(37)
    buffer_load_dwordx4 v4, s[36:39], s51 offen nt lds
    s_add_u32 m0, m0, 1024
    s_xor_b32 s51, s44, 1280
    s_waitcnt vmcnt(37)
    buffer_load_dwordx4 v5, s[36:39], s51 offen nt lds
    s_add_u32 m0, m0, 1024
    s_xor_b32 s51, s44, 65536
    s_waitcnt vmcnt(37)
    buffer_load_dwordx4 v2, s[36:39], s51 offen nt lds
    s_add_u32 m0, m0, 1024
    s_xor_b32 s51, s44, 66560
    s_waitcnt vmcnt(37)
    buffer_load_dwordx4 v3, s[36:39], s51 offen nt lds
    s_add_i32 s48, s47, -8
    v_max_i32 v6, s48, v6
    ds_write_b32 v7, v6
    s_add_u32 m0, m0, 1024
    s_xor_b32 s51, s44, 65792
    s_waitcnt vmcnt(37)
    buffer_load_dwordx4 v4, s[36:39], s51 offen nt lds
    s_add_u32 m0, m0, 1024
    s_xor_b32 s51, s44, 66816
    s_waitcnt vmcnt(37)
    buffer_load_dwordx4 v5, s[36:39], s51 offen nt lds
    s_add_u32 m0, m0, 1024
    s_xor_b32 s51, s44, 2048
    s_waitcnt vmcnt(37)
    buffer_load_dwordx4 v2, s[36:39], s51 offen nt lds
    s_add_u32 m0, m0, 1024
    s_xor_b32 s51, s44, 3072
    s_waitcnt vmcnt(37)
    buffer_load_dwordx4 v3, s[36:39], s51 offen nt lds
    s_add_i32 s48, s47, -7
    v_max_i32 v6, s48, v6
    ds_write_b32 v7, v6
    s_add_u32 m0, m0, 1024
    s_xor_b32 s51, s44, 2304
    s_waitcnt vmcnt(37)
    buffer_load_dwordx4 v4, s[36:39], s51 offen nt lds
    s_add_u32 m0, m0, 1024
    s_xor_b32 s51, s44, 3328
    s_waitcnt vmcnt(37)
    buffer_load_dwordx4 v5, s[36:39], s51 offen nt lds
    s_add_u32 m0, m0, 1024
    s_xor_b32 s51, s44, 67584
    s_waitcnt vmcnt(37)
    buffer_load_dwordx4 v2, s[36:39], s51 offen nt lds
    s_add_u32 m0, m0, 1024
    s_xor_b32 s51, s44, 68608
    s_waitcnt vmcnt(37)
    buffer_load_dwordx4 v3, s[36:39], s51 offen nt lds
    s_add_i32 s48, s47, -6
    v_max_i32 v6, s48, v6
    ds_write_b32 v7, v6
    s_add_u32 m0, m0, 1024
    s_xor_b32 s51, s44, 67840
    s_waitcnt vmcnt(37)
    buffer_load_dwordx4 v4, s[36:39], s51 offen nt lds
    s_add_u32 m0, m0, 1024
    s_xor_b32 s51, s44, 68864
    s_waitcnt vmcnt(37)
    buffer_load_dwordx4 v5, s[36:39], s51 offen nt lds
    s_add_u32 s47, s47, 4
    s_branch L_ld_unit
L_ld_phase:
    s_cmp_lg_u32 s57, 0
    s_cbranch_scc1 L_ld_pool
    s_mov_b32 s57, 1
    s_mov_b64 s[36:37], s[40:41]
    s_mov_b32 s44, s62
    s_mov_b32 s58, 0
    v_mov_b32 v2, v1
    v_mov_b32 v3, v1
    v_mov_b32 v4, v1
    v_mov_b32 v5, v1
    s_branch L_ld_same
L_ld_pool:
L_ld_ticket:
    s_waitcnt lgkmcnt(0)
    s_cmp_ge_u32 s49, 15
    s_cbranch_scc1 L_ld_done
    s_add_u32 s35, s49, 1
    v_readlane_b32 s50, v16, s49
    v_readlane_b32 s58, v14, s49
    v_readlane_b32 s59, v14, s35
    s_mov_b32 s61, 0
    s_mov_b32 s44, s50
L_ld_punit:
    s_lshr_b32 s48, s47, 3
    s_lshl_b32 s48, s48, 1
    s_sub_u32 s48, s48, 6
    s_cmp_ge_i32 s46, s48
    s_cbranch_scc1 L_ld_pcredit_ok
L_ld_pcredit:
    ds_read_b128 v[8:11], v7 offset:16
    s_sub_u32 s96, s96, 1
    s_cbranch_scc1 L_end
    s_waitcnt lgkmcnt(0)
    v_min3_u32 v8, v8, v9, v10
    v_min_u32 v8, v8, v11
    s_nop 0
    v_readfirstlane_b32 s46, v8
    s_nop 0
    s_cmp_lt_i32 s46, s48
    s_cbranch_scc1 L_ld_pcredit
L_ld_pcredit_ok:
    s_waitcnt vmcnt(22)
    buffer_load_dwordx4 v18, s[64:67], s44 offen nt lds
    s_add_u32 m0, m0, 1024
    s_xor_b32 s51, s44, 1024
    s_waitcnt vmcnt(22)
    buffer_load_dwordx4 v19, s[64:67], s51 offen nt lds
    s_add_u32 m0, m0, 1024
    s_xor_b32 s51, s44, 256
    s_waitcnt vmcnt(22)
    buffer_load_dwordx4 v20, s[64:67], s51 offen nt lds
    s_add_i32 s48, s47, -5
    v_max_i32 v6, s48, v6
    ds_write_b32 v7, v6
    s_add_u32 m0, m0, 1024
    s_xor_b32 s51, s44, 1280
    s_waitcnt vmcnt(22)
    buffer_load_dwordx4 v21, s[64:67], s51 offen nt lds
    s_add_u32 m0, m0, 1024
    s_xor_b32 s51, s44, 65536
    s_waitcnt vmcnt(22)
    buffer_load_dwordx4 v18, s[64:67], s51 offen nt lds
    s_sub_u32 s35, s59, s58
    s_add_u32 s35, s35, s61
    s_cmp_gt_u32 s35, 1
    s_cbranch_scc1 L_ld_ask1
    s_mov_b32 s49, 1
    s_atomic_add s49, s[32:33], s56 glc
    s_mov_b32 s61, 64
L_ld_ask1:
    s_add_u32 m0, m0, 1024
    s_xor_b32 s51, s44, 66560
    s_waitcnt vmcnt(22)
    buffer_load_dwordx4 v19, s[64:67], s51 offen nt lds
    s_add_u32 m0, m0, 1024
    s_xor_b32 s51, s44, 65792
    s_waitcnt vmcnt(22)
    buffer_load_dwordx4 v20, s[64:67], s51 offen nt lds
    s_add_i32 s48, s47, -4
    v_max_i32 v6, s48, v6
    ds_write_b32 v7, v6
    s_add_u32 m0, m0, 1024
    s_xor_b32 s51, s44, 66816
    s_waitcnt vmcnt(22)
    buffer_load_dwordx4 v21, s[64:67], s51 offen nt lds
    s_add_u32 m0, m0, 1024
    s_waitcnt vmcnt(22)
    buffer_load_dwordx4 v1, s[40:43], s44 offen nt lds
    s_add_u32 m0, m0, 1024
    s_xor_b32 s51, s44, 1024
    s_waitcnt vmcnt(22)
    buffer_load_dwordx4 v1, s[40:43], s51 offen nt lds
    s_add_u32 m0, m0, 1024
    s_xor_b32 s51, s44, 256
    s_waitcnt vmcnt(22)
    buffer_load_dwordx4 v1, s[40:43], s51 offen nt lds
    s_add_i32 s48, s47, -3
    v_max_i32 v6, s48, v6
    ds_write_b32 v7, v6
    s_add_u32 m0, m0, 1024
    s_xor_b32 s51, s44, 1280
    s_waitcnt vmcnt(22)
    buffer_load_dwordx4 v1, s[40:43], s51 offen nt lds
    s_add_u32 m0, m0, 1024
    s_xor_b32 s51, s44, 65536
    s_waitcnt vmcnt(22)
    buffer_load_dwordx4 v1, s[40:43], s51 offen nt lds
    s_add_u32 m0, m0, 1024
    s_xor_b32 s51, s44, 66560
    s_waitcnt vmcnt(22)
    buffer_load_dwordx4 v1, s[40:43], s51 offen nt lds
    s_add_u32 m0, m0, 1024
    s_xor_b32 s51, s44, 65792
    s_waitcnt vmcnt(22)
    buffer_load_dwordx4 v1, s[40:43], s51 offen nt lds
    s_add_i32 s48, s47, -2
    v_max_i32 v6, s48, v6
    ds_write_b32 v7, v6
    s_add_u32 m0, m0, 1024
    s_xor_b32 s51, s44, 66816
    s_waitcnt vmcnt(22)
    buffer_load_dwordx4 v1, s[40:43], s51 offen nt lds
    s_add_u32 s47, s47, 4
    s_add_u32 m0, m0, 1024
    s_and_b32 m0, m0, 131071
    s_add_u32 s58, s58, 1
    s_cmp_lt_u32 s58, s59
    s_cbranch_scc0 L_ld_ticket
    s_ff1_i32_b32 s50, s58
    s_add_u32 s50, s50, 16
    v_readlane_b32 s50, v15, s50
    s_nop 0
    s_xor_b32 s44, s44, s50
    s_branch L_ld_punit
L_ld_done:
    v_mov_b32 v8, s47
    ds_write_b32 v7, v8 offset:4
    s_add_u32 s48, s47, 5
    s_lshr_b32 s48, s48, 3
    s_lshl_b32 s48, s48, 1
    s_sub_u32 s48, s48, 6
    s_cmp_ge_i32 s46, s48
    s_cbranch_scc1 L_ld_wcredit_ok
L_ld_wcredit:
    ds_read_b128 v[8:11], v7 offset:16
    s_sub_u32 s96, s96, 1
    s_cbranch_scc1 L_end
    s_waitcnt lgkmcnt(0)
    v_min3_u32 v8, v8, v9, v10
    v_min_u32 v8, v8, v11
    s_nop 0
    v_readfirstlane_b32 s46, v8
    s_nop 0
    s_cmp_lt_i32 s46, s48
    s_cbranch_scc1 L_ld_wcredit
L_ld_wcredit_ok:
    s_add_i32 s48, s47, -5
    v_max_i32 v6, s48, v6
    s_waitcnt vmcnt(20)
    ds_write_b32 v7, v6
    s_add_i32 s48, s47, -4
    v_max_i32 v6, s48, v6
    s_waitcnt vmcnt(16)
    ds_write_b32 v7, v6
    s_add_i32 s48, s47, -3
    v_max_i32 v6, s48, v6
    s_waitcnt vmcnt(12)
    ds_write_b32 v7, v6
    s_add_i32 s48, s47, -2
    v_max_i32 v6, s48, v6
    s_waitcnt vmcnt(8)
    ds_write_b32 v7, v6
    s_waitcnt vmcnt(6)
    s_mov_b32 s35, m0
    s_mov_b32 m0, 131136
    s_mov_b64 exec, 255
    buffer_load_dword v25, s[76:79], s54 offen lds
    s_mov_b32 m0, s35
    s_mov_b64 exec, -1
    s_waitcnt vmcnt(6)
    buffer_load_dwordx4 v23, s[68:71], s52 offen offset:0 nt lds
    s_add_i32 s48, s47, -1
    v_max_i32 v6, s48, v6
    s_waitcnt vmcnt(6)
    ds_write_b32 v7, v6
    buffer_load_dwordx4 v23, s[68:71], s52 offen offset:1024 nt lds
    s_waitcnt vmcnt(6)
    buffer_load_dwordx4 v23, s[68:71], s52 offen offset:2048 nt lds
    s_waitcnt vmcnt(6)
    buffer_load_dwordx4 v23, s[68:71], s52 offen offset:3072 nt lds
    s_add_u32 m0, m0, 4096
    s_and_b32 m0, m0, 131071
    s_add_u32 s52, s52, 0x8000
    s_waitcnt vmcnt(6)
    buffer_load_dwordx4 v23, s[68:71], s52 offen offset:0 nt lds
    s_add_i32 s48, s47, 0
    v_max_i32 v6, s48, v6
    s_waitcnt vmcnt(6)
    ds_write_b32 v7, v6
    buffer_load_dwordx4 v23, s[68:71], s52 offen offset:1024 nt lds
    buffer_load_dwordx4 v23, s[68:71], s52 offen offset:2048 nt lds
    buffer_load_dwordx4 v23, s[68:71], s52 offen offset:3072 nt lds
    s_add_u32 m0, m0, 4096
    s_and_b32 m0, m0, 131071
    s_add_u32 s52, s52, 0x8000
    buffer_load_dwordx4 v23, s[68:71], s52 offen offset:0 nt lds
    buffer_load_dwordx4 v23, s[68:71], s52 offen offset:1024 nt lds
    buffer_load_dwordx4 v23, s[68:71], s52 offen offset:2048 nt lds
    buffer_load_dwordx4 v23, s[68:71], s52 offen offset:3072 nt lds
    s_add_u32 m0, m0, 4096
    s_and_b32 m0, m0, 131071
    s_add_u32 s52, s52, 0x8000
    buffer_load_dwordx4 v23, s[68:71], s52 offen offset:0 nt lds
    buffer_load_dwordx4 v23, s[68:71], s52 offen offset:1024 nt lds
    buffer_load_dwordx4 v23, s[68:71], s52 offen offset:2048 nt lds
    s_barrier
    buffer_load_dwordx4 v23, s[68:71], s52 offen offset:3072 nt lds
    s_add_u32 m0, m0, 4096
    s_and_b32 m0, m0, 131071
    s_nop 0
    buffer_load_dwordx4 v24, s[72:75], s53 offen offset:0 nt lds
    buffer_load_dwordx4 v24, s[72:75], s53 offen offset:1024 nt lds
    buffer_load_dwordx4 v24, s[72:75], s53 offen offset:2048 nt lds
    buffer_load_dwordx4 v24, s[72:75], s53 offen offset:3072 nt lds
    s_add_u32 m0, m0, 4096
    s_and_b32 m0, m0, 131071
    s_add_u32 s53, s53, 4096
    buffer_load_dwordx4 v24, s[72:75], s53 offen offset:0 nt lds
    buffer_load_dwordx4 v24, s[72:75], s53 offen offset:1024 nt lds
    buffer_load_dwordx4 v24, s[72:75], s53 offen offset:2048 nt lds
    v_add_u32 v6, 6, v6
    s_waitcnt vmcnt(0)
    ds_write_b32 v7, v6
    s_endpgm
L_notloader:
    v_lshrrev_b32 v1, 4, v0
    v_and_b32 v2, 15, v0
    v_lshrrev_b32 v3, 3, v0
    s_cmp_eq_u32 s3, 5
    s_cbranch_scc1 L_aux
    s_cmp_eq_u32 s3, 6
    s_cbranch_scc1 L_bal
    s_sub_u32 s3, s3, 1
    s_cmp_lg_u32 s3, 0
    s_cbranch_scc1 L_c_noq
    v_lshlrev_b32 v111, 4, v2
    v_lshl_add_u32 v9, v1, 17, v111
    s_lshl_b32 s97, s5, 19
    s_lshl_b32 s35, s4, 8
    s_add_u32 s97, s97, s35
    s_lshl_b32 s98, s5, 7
    s_add_u32 s99, s98, 64
    s_mov_b32 s42, 4194304
    s_mov_b32 s43, 0x20000
    s_waitcnt lgkmcnt(0)
    s_mov_b32 s40, s14
    s_and_b32 s41, s15, 0xffff
    buffer_load_dwordx4 v[128:131], v9, s[40:43], s97 offen nt
    s_load_dwordx16 s[48:63], s[8:9], s98
    s_load_dwordx16 s[64:79], s[8:9], s99
    s_load_dword s7, s[32:33], 0
    s_add_u32 s97, s97, 8192
    buffer_load_dwordx4 v[132:135], v9, s[40:43], s97 offen nt
    s_add_u32 s97, s97, 8192
    buffer_load_dwordx4 v[136:139], v9, s[40:43], s97 offen nt
    s_add_u32 s97, s97, 8192
    buffer_load_dwordx4 v[140:143], v9, s[40:43], s97 offen nt
    s_add_u32 s97, s97, 8192
    buffer_load_dwordx4 v[144:147], v9, s[40:43], s97 offen nt
    s_add_u32 s97, s97, 8192
    buffer_load_dwordx4 v[148:151], v9, s[40:43], s97 offen nt
    s_add_u32 s97, s97, 8192
    buffer_load_dwordx4 v[152:155], v9, s[40:43], s97 offen nt
    s_add_u32 s97, s97, 8192
    buffer_load_dwordx4 v[156:159], v9, s[40:43], s97 offen nt
    s_add_u32 s97, s97, 8192
    buffer_load_dwordx4 v[160:163], v9, s[40:43], s97 offen nt
    s_add_u32 s97, s97, 8192
    buffer_load_dwordx4 v[164:167], v9, s[40:43], s97 offen nt
    s_add_u32 s97, s97, 8192
    buffer_load_dwordx4 v[168:171], v9, s[40:43], s97 offen nt
    s_add_u32 s97, s97, 8192
    buffer_load_dwordx4 v[172:175], v9, s[40:43], s97 offen nt
    s_add_u32 s97, s97, 8192
    buffer_load_dwordx4 v[176:179], v9, s[40:43], s97 offen nt
    s_add_u32 s97, s97, 8192
    buffer_load_dwordx4 v[180:183], v9, s[40:43], s97 offen nt
    s_add_u32 s97, s97, 8192
    buffer_load_dwordx4 v[184:187], v9, s[40:43], s97 offen nt
    s_add_u32 s97, s97, 8192
    buffer_load_dwordx4 v[188:191], v9, s[40:43], s97 offen nt
    s_barrier
    v_and_b32 v110, 1, v0
    v_lshlrev_b32 v110, 4, v110
    v_mov_b32 v111, 0xffff
    v_lshlrev_b32 v110, v110, v111
    v_bfe_u32 v111, v0, 1, 2
    v_cmp_eq_u32 vcc, 0, v111
    s_nop 1
    v_cndmask_b32 v4, 0, v110, vcc
    v_cmp_eq_u32 vcc, 1, v111
    s_nop 1
    v_cndmask_b32 v5, 0, v110, vcc
    v_cmp_eq_u32 vcc, 2, v111
    s_nop 1
    v_cndmask_b32 v6, 0, v110, vcc
    v_cmp_eq_u32 vcc, 3, v111
    s_nop 1
    v_cndmask_b32 v7, 0, v110, vcc
    s_mov_b32 s36, s32
    s_and_b32 s37, s33, 0xffff
    s_mov_b32 s38, 2097152
    s_mov_b32 s39, 0x20000
    s_cmp_lg_u32 s5, 0
    s_cbranch_scc1 L_nozero
    s_add_u32 s35, s35, 16384
    v_mov_b32 v10, 0
    s_mov_b64 exec, 1
    buffer_store_dword v10, off, s[36:39], s35 sc1
    s_mov_b64 exec, -1
L_nozero:
    s_waitcnt lgkmcnt(0)
    s_mov_b32 exec_lo, 65535
    s_mov_b32 exec_hi, 0
    v_mov_b32 v112, s48
    v_mov_b32 v113, s49
    v_mov_b32 v114, s50
    v_mov_b32 v115, s51
    v_mov_b32 v116, s52
    v_mov_b32 v117, s53
    v_mov_b32 v118, s54
    v_mov_b32 v119, s55
    s_mov_b32 exec_lo, 4294901760
    s_mov_b32 exec_hi, 0
    v_mov_b32 v112, s56
    v_mov_b32 v113, s57
    v_mov_b32 v114, s58
    v_mov_b32 v115, s59
    v_mov_b32 v116, s60
    v_mov_b32 v117, s61
    v_mov_b32 v118, s62
    v_mov_b32 v119, s63
    s_mov_b32 exec_lo, 0
    s_mov_b32 exec_hi, 65535
    v_mov_b32 v112, s64
    v_mov_b32 v113, s65
    v_mov_b32 v114, s66
    v_mov_b32 v115, s67
    v_mov_b32 v116, s68
    v_mov_b32 v117, s69
    v_mov_b32 v118, s70
    v_mov_b32 v119, s71
    s_mov_b32 exec_lo, 0
    s_mov_b32 exec_hi, 4294901760
    v_mov_b32 v112, s72
    v_mov_b32 v113, s73
    v_mov_b32 v114, s74
    v_mov_b32 v115, s75
    v_mov_b32 v116, s76
    v_mov_b32 v117, s77
    v_mov_b32 v118, s78
    v_mov_b32 v119, s79
    s_mov_b64 exec, -1
    s_add_u32 s7, s7, 0x11111111
    s_bfe_u32 s76, s7, 262144
    s_bfe_u32 s77, s7, 262148
    s_bfe_u32 s78, s7, 262152
    s_bfe_u32 s79, s7, 262156
    s_mov_b32 s48, 0x01000100
    s_mov_b32 s49, 0x03020302
    v_perm_b32 v110, v112, v112, s48
    v_and_b32 v84, v110, v4
    v_and_b32 v85, v110, v5
    v_and_b32 v86, v110, v6
    v_and_b32 v87, v110, v7
    s_waitcnt vmcnt(15)
    s_nop 0
    v_mfma_f32_16x16x32_bf16 v[48:51], v[84:87], v[128:131], 0
    v_perm_b32 v110, v112, v112, s49
    v_and_b32 v88, v110, v4
    v_and_b32 v89, v110, v5
    v_and_b32 v90, v110, v6
    v_and_b32 v91, v110, v7
    s_waitcnt vmcnt(14)
    s_nop 0
    v_mfma_f32_16x16x32_bf16 v[48:51], v[88:91], v[132:135], v[48:51]
    v_perm_b32 v110, v113, v113, s48
    v_and_b32 v92, v110, v4
    v_and_b32 v93, v110, v5
    v_and_b32 v94, v110, v6
    v_and_b32 v95, v110, v7
    s_waitcnt vmcnt(13)
    s_nop 0
    v_mfma_f32_16x16x32_bf16 v[48:51], v[92:95], v[136:139], v[48:51]
    v_perm_b32 v110, v113, v113, s49
    v_and_b32 v96, v110, v4
    v_and_b32 v97, v110, v5
    v_and_b32 v98, v110, v6
    v_and_b32 v99, v110, v7
    s_waitcnt vmcnt(12)
    s_nop 0
    v_mfma_f32_16x16x32_bf16 v[48:51], v[96:99], v[140:143], v[48:51]
    v_perm_b32 v110, v114, v114, s48
    v_and_b32 v84, v110, v4
    v_and_b32 v85, v110, v5
    v_and_b32 v86, v110, v6
    v_and_b32 v87, v110, v7
    s_waitcnt vmcnt(11)
    s_nop 0
    v_mfma_f32_16x16x32_bf16 v[48:51], v[84:87], v[144:147], v[48:51]
    v_perm_b32 v110, v114, v114, s49
    v_and_b32 v88, v110, v4
    v_and_b32 v89, v110, v5
    v_and_b32 v90, v110, v6
    v_and_b32 v91, v110, v7
    s_waitcnt vmcnt(10)
    s_nop 0
    v_mfma_f32_16x16x32_bf16 v[48:51], v[88:91], v[148:151], v[48:51]
    v_perm_b32 v110, v115, v115, s48
    v_and_b32 v92, v110, v4
    v_and_b32 v93, v110, v5
    v_and_b32 v94, v110, v6
    v_and_b32 v95, v110, v7
    s_waitcnt vmcnt(9)
    s_nop 0
    v_mfma_f32_16x16x32_bf16 v[48:51], v[92:95], v[152:155], v[48:51]
    v_perm_b32 v110, v115, v115, s49
    v_and_b32 v96, v110, v4
    v_and_b32 v97, v110, v5
    v_and_b32 v98, v110, v6
    v_and_b32 v99, v110, v7
    s_waitcnt vmcnt(8)
    s_nop 0
    v_mfma_f32_16x16x32_bf16 v[48:51], v[96:99], v[156:159], v[48:51]
    v_perm_b32 v110, v116, v116, s48
    v_and_b32 v84, v110, v4
    v_and_b32 v85, v110, v5
    v_and_b32 v86, v110, v6
    v_and_b32 v87, v110, v7
    s_waitcnt vmcnt(7)
    s_nop 0
    v_mfma_f32_16x16x32_bf16 v[48:51], v[84:87], v[160:163], v[48:51]
    v_perm_b32 v110, v116, v116, s49
    v_and_b32 v88, v110, v4
    v_and_b32 v89, v110, v5
    v_and_b32 v90, v110, v6
    v_and_b32 v91, v110, v7
    s_waitcnt vmcnt(6)
    s_nop 0
    v_mfma_f32_16x16x32_bf16 v[48:51], v[88:91], v[164:167], v[48:51]
    v_perm_b32 v110, v117, v117, s48
    v_and_b32 v92, v110, v4
    v_and_b32 v93, v110, v5
    v_and_b32 v94, v110, v6
    v_and_b32 v95, v110, v7
    s_waitcnt vmcnt(5)
    s_nop 0
    v_mfma_f32_16x16x32_bf16 v[48:51], v[92:95], v[168:171], v[48:51]
    v_perm_b32 v110, v117, v117, s49
    v_and_b32 v96, v110, v4
    v_and_b32 v97, v110, v5
    v_and_b32 v98, v110, v6
    v_and_b32 v99, v110, v7
    s_waitcnt vmcnt(4)
    s_nop 0
    v_mfma_f32_16x16x32_bf16 v[48:51], v[96:99], v[172:175], v[48:51]
    v_perm_b32 v110, v118, v118, s48
    v_and_b32 v84, v110, v4
    v_and_b32 v85, v110, v5
    v_and_b32 v86, v110, v6
    v_and_b32 v87, v110, v7
    s_waitcnt vmcnt(3)
    s_nop 0
    v_mfma_f32_16x16x32_bf16 v[48:51], v[84:87], v[176:179], v[48:51]
    v_perm_b32 v110, v118, v118, s49
    v_and_b32 v88, v110, v4
    v_and_b32 v89, v110, v5
    v_and_b32 v90, v110, v6
    v_and_b32 v91, v110, v7
    s_waitcnt vmcnt(2)
    s_nop 0
    v_mfma_f32_16x16x32_bf16 v[48:51], v[88:91], v[180:183], v[48:51]
    v_perm_b32 v110, v119, v119, s48
    v_and_b32 v92, v110, v4
    v_and_b32 v93, v110, v5
    v_and_b32 v94, v110, v6
    v_and_b32 v95, v110, v7
    s_waitcnt vmcnt(1)
    s_nop 0
    v_mfma_f32_16x16x32_bf16 v[48:51], v[92:95], v[184:187], v[48:51]
    v_perm_b32 v110, v119, v119, s49
    v_and_b32 v96, v110, v4
    v_and_b32 v97, v110, v5
    v_and_b32 v98, v110, v6
    v_and_b32 v99, v110, v7
    s_waitcnt vmcnt(0)
    s_nop 0
    v_mfma_f32_16x16x32_bf16 v[48:51], v[96:99], v[188:191], v[48:51]
    v_lshlrev_b32 v110, 5, v2
    v_lshl_add_u32 v110, v1, 4, v110
    s_lshl_b32 s48, s2, 9
    s_add_u32 s48, s48, 65536
    s_nop 3
    v_bfi_b32 v48, 15, s76, v48
    v_bfi_b32 v49, 15, s77, v49
    v_bfi_b32 v50, 15, s78, v50
    v_bfi_b32 v51, 15, s79, v51
    s_mov_b32 exec_hi, 0
    buffer_store_dwordx4 v[48:51], v110, s[36:39], s48 offen sc1
    s_mov_b64 exec, -1
    v_mov_b32 v109, 131072
    v_mov_b32 v100, 0
    v_mov_b32 v101, 0xff800000
    v_mov_b32 v103, 1069066811
    v_mov_b32 v44, 0
    v_mov_b32 v45, 0
    v_mov_b32 v46, 0
    v_mov_b32 v47, 0
    v_xor_b32 v110, v1, v2
    v_lshlrev_b32 v110, 4, v110
    v_lshl_add_u32 v104, v2, 8, v110
    v_lshlrev_b32 v110, 4, v2
    v_lshl_add_u32 v108, v1, 10, v110
    s_lshl_b32 s48, s3, 12
    v_add_u32 v141, s48, v104
    s_add_u32 s48, s48, 98304
    v_add_u32 v142, s48, v108
    s_and_b32 s71, s3, 2
    s_add_u32 s71, s71, s3
    s_lshl_b32 s48, s71, 12
    s_add_u32 s48, s48, 65536
    v_add_u32 v104, s48, v104
    v_add_u32 v108, s48, v108
    s_add_u32 s71, s71, 497
    s_lshl_b32 s48, s3, 2
    v_add_u32 v10, s48, v109
    v_mov_b32 v11, 0
    s_mul_i32 s48, s3, 3968
    s_add_u32 s48, s48, 133840
    v_lshl_add_u32 v143, v1, 4, s48
    s_add_u32 s50, s3, 1
    s_mov_b32 s51, 0
    s_mov_b32 s57, -1
    s_mov_b32 s72, 62
    s_mov_b32 s74, 0x10001
    s_mov_b32 s75, 0x10001
    v_lshrrev_b32 v110, 5, v0
    v_and_b32 v111, 31, v0
    v_lshlrev_b32 v110, 11, v110
    v_lshl_add_u32 v110, v111, 4, v110
    s_lshl_b32 s48, s4, 12
    s_add_u32 s48, s48, 65536
    v_mov_b32 v109, 131072
L_q_early:
    ds_read_b32 v112, v109 offset:0
    s_sub_u32 s96, s96, 1
    s_cbranch_scc1 L_end
    s_waitcnt lgkmcnt(0)
    v_readfirstlane_b32 s35, v112
    s_nop 0
    s_cmp_lt_u32 s35, 9
    s_cbranch_scc1 L_q_early
L_q_poll:
    buffer_load_dwordx4 v[160:163], v110, s[36:39], s48 offen offset:0 sc1
    buffer_load_dwordx4 v[164:167], v110, s[36:39], s48 offen offset:512 sc1
    buffer_load_dwordx4 v[168:171], v110, s[36:39], s48 offen offset:1024 sc1
    buffer_load_dwordx4 v[172:175], v110, s[36:39], s48 offen offset:1536 sc1
    s_sub_u32 s96, s96, 1
    s_cbranch_scc1 L_end
    s_waitcnt vmcnt(0)
    v_xor_b32 v160, s76, v160
    v_xor_b32 v161, s77, v161
    v_xor_b32 v162, s78, v162
    v_xor_b32 v163, s79, v163
    v_xor_b32 v164, s76, v164
    v_xor_b32 v165, s77, v165
    v_xor_b32 v166, s78, v166
    v_xor_b32 v167, s79, v167
    v_xor_b32 v168, s76, v168
    v_xor_b32 v169, s77, v169
    v_xor_b32 v170, s78, v170
    v_xor_b32 v171, s79, v171
    v_xor_b32 v172, s76, v172
    v_xor_b32 v173, s77, v173
    v_xor_b32 v174, s78, v174
    v_xor_b32 v175, s79, v175
    v_or3_b32 v112, v160, v161, v162
    v_or3_b32 v112, v112, v163, v164
    v_or3_b32 v112, v112, v165, v166
    v_or3_b32 v112, v112, v167, v168
    v_or3_b32 v112, v112, v169, v170
    v_or3_b32 v112, v112, v171, v172
    v_or3_b32 v112, v112, v173, v174
    v_or_b32 v112, v112, v175
    v_and_b32 v112, 15, v112
    v_cmp_ne_u32 vcc, 0, v112
    s_cbranch_vccnz L_q_poll
    v_add_f32 v160, v160, v164
    v_add_f32 v168, v168, v172
    v_add_f32 v161, v161, v165
    v_add_f32 v169, v169, v173
    v_add_f32 v162, v162, v166
    v_add_f32 v170, v170, v174
    v_add_f32 v163, v163, v167
    v_add_f32 v171, v171, v175
    v_add_f32 v160, v160, v168
    v_add_f32 v161, v161, v169
    v_add_f32 v162, v162, v170
    v_add_f32 v163, v163, v171
    v_permlane32_swap_b32 v160, v164
    v_permlane32_swap_b32 v161, v165
    v_permlane32_swap_b32 v162, v166
    v_permlane32_swap_b32 v163, v167
    v_add_f32 v160, v160, v164
    v_add_f32 v161, v161, v165
    v_add_f32 v162, v162, v166
    v_add_f32 v163, v163, v167
    v_cvt_pk_bf16_f32 v160, v160, v161
    v_cvt_pk_bf16_f32 v161, v162, v163
    v_lshlrev_b32 v111, 3, v111
    v_add_u32 v111, 131136, v111
    v_mov_b32 v109, 131072
    v_mov_b32 v110, 1
    s_mov_b32 exec_hi, 0
    ds_write_b64 v111, v[160:161]
    s_mov_b64 exec, -1
    ds_write_b32 v109, v110 offset:8
    s_branch L_c_ready
L_c_noq:
    s_waitcnt lgkmcnt(0)
    s_load_dword s7, s[32:33], 0
    s_barrier
    v_and_b32 v110, 1, v0
    v_lshlrev_b32 v110, 4, v110
    v_mov_b32 v111, 0xffff
    v_lshlrev_b32 v110, v110, v111
    v_bfe_u32 v111, v0, 1, 2
    v_cmp_eq_u32 vcc, 0, v111
    s_nop 1
    v_cndmask_b32 v4, 0, v110, vcc
    v_cmp_eq_u32 vcc, 1, v111
    s_nop 1
    v_cndmask_b32 v5, 0, v110, vcc
    v_cmp_eq_u32 vcc, 2, v111
    s_nop 1
    v_cndmask_b32 v6, 0, v110, vcc
    v_cmp_eq_u32 vcc, 3, v111
    s_nop 1
    v_cndmask_b32 v7, 0, v110, vcc
    s_mov_b32 s36, s32
    s_and_b32 s37, s33, 0xffff
    s_mov_b32 s38, 2097152
    s_mov_b32 s39, 0x20000
    s_waitcnt lgkmcnt(0)
    s_add_u32 s7, s7, 0x11111111
L_c_common:
    v_mov_b32 v109, 131072
    v_mov_b32 v100, 0
    v_mov_b32 v101, 0xff800000
    v_mov_b32 v103, 1069066811
    v_mov_b32 v44, 0
    v_mov_b32 v45, 0
    v_mov_b32 v46, 0
    v_mov_b32 v47, 0
    v_xor_b32 v110, v1, v2
    v_lshlrev_b32 v110, 4, v110
    v_lshl_add_u32 v104, v2, 8, v110
    v_lshlrev_b32 v110, 4, v2
    v_lshl_add_u32 v108, v1, 10, v110
    s_lshl_b32 s48, s3, 12
    v_add_u32 v141, s48, v104
    s_add_u32 s48, s48, 98304
    v_add_u32 v142, s48, v108
    s_and_b32 s71, s3, 2
    s_add_u32 s71, s71, s3
    s_lshl_b32 s48, s71, 12
    s_add_u32 s48, s48, 65536
    v_add_u32 v104, s48, v104
    v_add_u32 v108, s48, v108
    s_add_u32 s71, s71, 497
    s_lshl_b32 s48, s3, 2
    v_add_u32 v10, s48, v109
    v_mov_b32 v11, 0
    s_mul_i32 s48, s3, 3968
    s_add_u32 s48, s48, 133840
    v_lshl_add_u32 v143, v1, 4, s48
    s_add_u32 s50, s3, 1
    s_mov_b32 s51, 0
    s_mov_b32 s57, -1
    s_mov_b32 s72, 62
    s_mov_b32 s74, 0x10001
    s_mov_b32 s75, 0x10001
L_c_ready:
    v_lshlrev_b32 v111, 4, v1
    v_add_u32 v111, 131136, v111
L_qwait:
    ds_read_b32 v110, v109 offset:8
    s_sub_u32 s96, s96, 1
    s_cbranch_scc1 L_end
    s_waitcnt lgkmcnt(0)
    v_readfirstlane_b32 s35, v110
    s_nop 0
    s_cmp_lt_u32 s35, 1
    s_cbranch_scc1 L_qwait
    ds_read_b128 v[12:15], v111 offset:0
    ds_read_b128 v[16:19], v111 offset:64
    ds_read_b128 v[20:23], v111 offset:128
    ds_read_b128 v[24:27], v111 offset:192
L_k_loop:
    v_xor_b32 v105, 64, v141
    v_xor_b32 v106, 128, v141
    v_xor_b32 v107, 192, v141
    s_cmp_ge_u32 s51, s50
    s_cbranch_scc1 L_wk0_ok
L_wk0:
    ds_read_b64 v[110:111], v109
    s_sub_u32 s96, s96, 1
    s_cbranch_scc1 L_end
    s_waitcnt lgkmcnt(0)
    v_readfirstlane_b32 s57, v111
    v_readfirstlane_b32 s51, v110
    s_nop 0
    s_cmp_lt_u32 s51, s50
    s_cbranch_scc1 L_wk0
L_wk0_ok:
    ds_read_b128 v[52:55], v141
    ds_read_b128 v[56:59], v105
    ds_read_b128 v[60:63], v106
    ds_read_b128 v[64:67], v107
    s_add_u32 s50, s50, 4
    v_add_u32 v141, 16384, v141
    v_and_b32 v141, 131071, v141
    s_waitcnt lgkmcnt(3)
    v_mfma_f32_16x16x32_bf16 v[48:51], v[52:55], v[12:15], 0
    s_waitcnt lgkmcnt(2)
    v_mfma_f32_16x16x32_bf16 v[48:51], v[56:59], v[16:19], v[48:51]
    s_waitcnt lgkmcnt(1)
    v_mfma_f32_16x16x32_bf16 v[48:51], v[60:63], v[20:23], v[48:51]
    s_waitcnt lgkmcnt(0)
    v_mfma_f32_16x16x32_bf16 v[48:51], v[64:67], v[24:27], v[48:51]
    v_add_u32 v11, 1, v11
    s_sub_u32 s72, s72, 1
    ds_write_b32 v10, v11 offset:16
    s_nop 4
    v_cvt_pk_bf16_f32 v110, v48, v49
    v_cvt_pk_bf16_f32 v111, v50, v51
    v_lshlrev_b32 v48, 16, v110
    v_and_b32 v49, 0xffff0000, v110
    v_lshlrev_b32 v50, 16, v111
    v_and_b32 v51, 0xffff0000, v111
    v_mul_f32 v48, 1035273459, v48
    v_mul_f32 v49, 1035273459, v49
    v_mul_f32 v50, 1035273459, v50
    v_mul_f32 v51, 1035273459, v51
    v_cvt_pk_bf16_f32 v110, v48, v49
    v_cvt_pk_bf16_f32 v111, v50, v51
    v_lshlrev_b32 v48, 16, v110
    v_and_b32 v49, 0xffff0000, v110
    v_lshlrev_b32 v50, 16, v111
    v_and_b32 v51, 0xffff0000, v111
    v_max3_f32 v101, v101, v48, v49
    s_mov_b64 exec, s[74:75]
    ds_write_b128 v143, v[48:51]
    s_mov_b64 exec, -1
    v_max3_f32 v101, v101, v50, v51
    v_add_u32 v143, 64, v143
    s_cmp_lg_u32 s72, 0
    s_cbranch_scc1 L_k_loop
    v_max_f32_dpp v101, v101, v101 row_bcast:15 row_mask:0xa bank_mask:0xf
    s_nop 1
    v_max_f32_dpp v101, v101, v101 row_bcast:31 row_mask:0xc bank_mask:0xf
    s_nop 0
    v_readlane_b32 s48, v101, 63
    s_nop 1
    v_mov_b32 v101, s48
    v_mul_f32 v102, v101, v103
    v_subrev_u32 v143, 3968, v143
    s_mov_b32 s72, 62
    s_mov_b32 s64, s28
    s_and_b32 s65, s29, 0xffff
    s_mov_b32 s66, 1024
    s_mov_b32 s67, 0x20000
    v_and_b32 v110, 7, v0
    v_lshlrev_b32 v110, 9, v110
    v_lshl_add_u32 v136, v3, 4, v110
    s_mul_i32 s48, s3, 544
    s_add_u32 s48, s48, 131392
    v_lshlrev_b32 v110, 5, v2
    v_lshl_add_u32 v110, v1, 4, v110
    v_add_u32 v130, s48, v110
    v_lshl_add_u32 v131, v1, 2, s48
    v_mov_b32 v132, s48
    v_and_b32 v111, 3, v0
    v_mul_u32_u24 v110, 544, v111
    v_add_u32 v133, 131392, v110
    v_bfe_u32 v135, v0, 2, 3
    v_lshlrev_b32 v135, 4, v135
    s_lshl_b32 s48, s3, 7
    v_add3_u32 v134, v133, v135, s48
    s_lshl_b32 s55, s4, 12
    s_add_u32 s55, s55, s48
    s_add_u32 s55, s55, 524288
    s_lshl_b32 s60, s5, 9
    s_add_u32 s60, s60, s55
    v_lshlrev_b32 v110, 12, v2
    v_lshl_add_u32 v137, v1, 4, v110
    s_lshl_b32 s48, s5, 15
    s_lshl_b32 s49, s4, 7
    s_add_u32 s48, s48, s49
    s_lshl_b32 s49, s3, 5
    s_add_u32 s48, s48, s49
    s_add_u32 s62, s48, 1048576
    s_lshl_b32 s48, s3, 3
    s_add_u32 s48, s48, 133568
    v_lshl_add_u32 v138, v3, 5, s48
    v_lshlrev_b32 v139, 5, v0
    s_lshl_b32 s48, s5, 3
    s_lshr_b32 s49, s4, 4
    s_lshl_b32 s49, s49, 2
    s_add_u32 s48, s48, s49
    s_add_u32 s48, s48, s3
    s_and_b32 s49, s4, 8
    s_lshl_b32 s69, s48, 4
    s_add_u32 s69, s69, s49
    s_lshl_b32 s68, s48, 12
    s_lshl_b32 s49, s49, 1
    s_add_u32 s68, s68, s49
    s_add_u32 s68, s68, 1048576
    v_and_b32 v110, 1, v1
    v_and_b32 v140, 2, v1
    v_lshl_add_u32 v140, v110, 2, v140
    s_bfe_u32 s76, s7, 262144
    s_bfe_u32 s77, s7, 262148
    s_bfe_u32 s78, s7, 262152
    s_bfe_u32 s79, s7, 262156
    s_mov_b32 s61, 0xfffff000
    s_bfe_u32 s44, s7, 655360
    s_bfe_u32 s45, s7, 655368
    s_bfe_u32 s46, s7, 655376
    s_bfe_u32 s47, s7, 655382
    v_mov_b32 v8, 1023
L_v_loop:
    ds_read_b128 v[48:51], v143
    v_add_u32 v143, 64, v143
    s_waitcnt lgkmcnt(0)
    v_fma_f32 v48, v48, v103, -v102
    v_fma_f32 v49, v49, v103, -v102
    v_fma_f32 v50, v50, v103, -v102
    v_fma_f32 v51, v51, v103, -v102
    v_exp_f32 v48, v48
    v_exp_f32 v49, v49
    v_exp_f32 v50, v50
    v_exp_f32 v51, v51
    v_add_f32 v110, v48, v49
    v_add_f32 v111, v50, v51
    v_cvt_pk_bf16_f32 v48, v48, v48
    v_cvt_pk_bf16_f32 v49, v49, v49
    v_cvt_pk_bf16_f32 v50, v50, v50
    v_cvt_pk_bf16_f32 v51, v51, v51
    v_add_f32 v110, v110, v111
    v_add_f32 v100, v100, v110
    v_and_b32 v84, v48, v4
    v_and_b32 v85, v48, v5
    v_and_b32 v86, v48, v6
    v_and_b32 v87, v48, v7
    v_and_b32 v88, v49, v4
    v_and_b32 v89, v49, v5
    v_and_b32 v90, v49, v6
    v_and_b32 v91, v49, v7
    v_and_b32 v92, v50, v4
    v_and_b32 v93, v50, v5
    v_and_b32 v94, v50, v6
    v_and_b32 v95, v50, v7
    v_and_b32 v96, v51, v4
    v_and_b32 v97, v51, v5
    v_and_b32 v98, v51, v6
    v_and_b32 v99, v51, v7
    s_cmp_ge_u32 s51, s50
    s_cbranch_scc1 L_wv0_ok
L_wv0:
    ds_read_b64 v[110:111], v109
    s_sub_u32 s96, s96, 1
    s_cbranch_scc1 L_end
    s_waitcnt lgkmcnt(0)
    v_readfirstlane_b32 s57, v111
    v_readfirstlane_b32 s51, v110
    s_nop 0
    s_cmp_lt_u32 s51, s50
    s_cbranch_scc1 L_wv0
L_wv0_ok:
    ds_read_b128 v[68:71], v142 offset:0
    ds_read_b128 v[72:75], v142 offset:256
    ds_read_b128 v[76:79], v142 offset:512
    ds_read_b128 v[80:83], v142 offset:768
    s_add_u32 s50, s50, 4
    v_add_u32 v142, 16384, v142
    v_and_b32 v142, 131071, v142
    v_add_u32 v11, 1, v11
    s_sub_u32 s72, s72, 1
    s_waitcnt lgkmcnt(3)
    v_mfma_f32_16x16x32_bf16 v[44:47], v[84:87], v[68:71], v[44:47]
    s_waitcnt lgkmcnt(2)
    v_mfma_f32_16x16x32_bf16 v[44:47], v[88:91], v[72:75], v[44:47]
    s_waitcnt lgkmcnt(1)
    v_mfma_f32_16x16x32_bf16 v[44:47], v[92:95], v[76:79], v[44:47]
    s_waitcnt lgkmcnt(0)
    v_mfma_f32_16x16x32_bf16 v[44:47], v[96:99], v[80:83], v[44:47]
    ds_write_b32 v10, v11 offset:16
    s_cmp_lg_u32 s72, 0
    s_cbranch_scc1 L_v_loop
    s_mov_b32 s50, s71
    s_cmp_gt_u32 s50, s57
    s_cbranch_scc1 L_c_done
L_c_loop:
    v_xor_b32 v105, 64, v104
    v_xor_b32 v106, 128, v104
    v_xor_b32 v107, 192, v104
    s_cmp_ge_u32 s51, s50
    s_cbranch_scc1 L_wk_ok
L_wk:
    ds_read_b64 v[110:111], v109
    s_sub_u32 s96, s96, 1
    s_cbranch_scc1 L_end
    s_waitcnt lgkmcnt(0)
    v_readfirstlane_b32 s57, v111
    v_readfirstlane_b32 s51, v110
    s_cmp_gt_u32 s50, s57
    s_cbranch_scc1 L_c_done
    s_cmp_lt_u32 s51, s50
    s_cbranch_scc1 L_wk
L_wk_ok:
    ds_read_b128 v[52:55], v104
    ds_read_b128 v[56:59], v105
    ds_read_b128 v[60:63], v106
    ds_read_b128 v[64:67], v107
    s_add_u32 s50, s50, 2
    v_add_u32 v104, 32768, v104
    v_and_b32 v104, 131071, v104
    s_waitcnt lgkmcnt(3)
    v_mfma_f32_16x16x32_bf16 v[48:51], v[52:55], v[12:15], 0
    s_waitcnt lgkmcnt(2)
    v_mfma_f32_16x16x32_bf16 v[48:51], v[56:59], v[16:19], v[48:51]
    s_waitcnt lgkmcnt(1)
    v_mfma_f32_16x16x32_bf16 v[48:51], v[60:63], v[20:23], v[48:51]
    s_waitcnt lgkmcnt(0)
    v_mfma_f32_16x16x32_bf16 v[48:51], v[64:67], v[24:27], v[48:51]
    s_nop 7
    v_cvt_pk_bf16_f32 v110, v48, v49
    v_cvt_pk_bf16_f32 v111, v50, v51
    v_lshlrev_b32 v48, 16, v110
    v_and_b32 v49, 0xffff0000, v110
    v_lshlrev_b32 v50, 16, v111
    v_and_b32 v51, 0xffff0000, v111
    v_mul_f32 v48, 1035273459, v48
    v_mul_f32 v49, 1035273459, v49
    v_mul_f32 v50, 1035273459, v50
    v_mul_f32 v51, 1035273459, v51
    v_cvt_pk_bf16_f32 v110, v48, v49
    v_cvt_pk_bf16_f32 v111, v50, v51
    v_lshlrev_b32 v48, 16, v110
    v_and_b32 v49, 0xffff0000, v110
    v_lshlrev_b32 v50, 16, v111
    v_and_b32 v51, 0xffff0000, v111
    v_max3_f32 v110, v48, v49, v50
    v_max_f32 v110, v110, v51
    v_cmp_gt_f32 vcc, v110, v101
    s_cbranch_vccnz L_newmax
L_c_back:
    v_fma_f32 v48, v48, v103, -v102
    v_fma_f32 v49, v49, v103, -v102
    v_fma_f32 v50, v50, v103, -v102
    v_fma_f32 v51, v51, v103, -v102
    v_exp_f32 v48, v48
    v_exp_f32 v49, v49
    v_exp_f32 v50, v50
    v_exp_f32 v51, v51
    v_add_f32 v110, v48, v49
    v_add_f32 v111, v50, v51
    v_cvt_pk_bf16_f32 v48, v48, v48
    v_cvt_pk_bf16_f32 v49, v49, v49
    v_cvt_pk_bf16_f32 v50, v50, v50
    v_cvt_pk_bf16_f32 v51, v51, v51
    v_add_f32 v110, v110, v111
    v_add_f32 v100, v100, v110
    v_and_b32 v84, v48, v4
    v_and_b32 v85, v48, v5
    v_and_b32 v86, v48, v6
    v_and_b32 v87, v48, v7
    v_and_b32 v88, v49, v4
    v_and_b32 v89, v49, v5
    v_and_b32 v90, v49, v6
    v_and_b32 v91, v49, v7
    v_and_b32 v92, v50, v4
    v_and_b32 v93, v50, v5
    v_and_b32 v94, v50, v6
    v_and_b32 v95, v50, v7
    v_and_b32 v96, v51, v4
    v_and_b32 v97, v51, v5
    v_and_b32 v98, v51, v6
    v_and_b32 v99, v51, v7
    s_cmp_ge_u32 s51, s50
    s_cbranch_scc1 L_wv_ok
L_wv:
    ds_read_b64 v[110:111], v109
    s_sub_u32 s96, s96, 1
    s_cbranch_scc1 L_end
    s_waitcnt lgkmcnt(0)
    v_readfirstlane_b32 s57, v111
    v_readfirstlane_b32 s51, v110
    s_nop 0
    s_cmp_lt_u32 s51, s50
    s_cbranch_scc1 L_wv
L_wv_ok:
    ds_read_b128 v[68:71], v108 offset:8192
    ds_read_b128 v[72:75], v108 offset:8448
    ds_read_b128 v[76:79], v108 offset:8704
    ds_read_b128 v[80:83], v108 offset:8960
    s_add_u32 s50, s50, 6
    v_add_u32 v108, 32768, v108
    v_and_b32 v108, 131071, v108
    v_add_u32 v11, 2, v11
    s_waitcnt lgkmcnt(3)
    v_mfma_f32_16x16x32_bf16 v[44:47], v[84:87], v[68:71], v[44:47]
    s_waitcnt lgkmcnt(2)
    v_mfma_f32_16x16x32_bf16 v[44:47], v[88:91], v[72:75], v[44:47]
    s_waitcnt lgkmcnt(1)
    v_mfma_f32_16x16x32_bf16 v[44:47], v[92:95], v[76:79], v[44:47]
    s_waitcnt lgkmcnt(0)
    v_mfma_f32_16x16x32_bf16 v[44:47], v[96:99], v[80:83], v[44:47]
    ds_write_b32 v10, v11 offset:16
    s_cmp_le_u32 s50, s57
    s_cbranch_scc1 L_c_loop
L_c_done:
    ds_write_b32 v131, v100 offset:512
    ds_write_b32 v132, v102 offset:528
    s_mov_b32 exec_hi, 0
    s_nop 1
    ds_write_b128 v130, v[44:47]
    s_mov_b64 exec, -1
    s_waitcnt lgkmcnt(0)
    s_barrier
    ds_read_b32 v101, v133 offset:528
    ds_read_b128 v[52:55], v133 offset:512
    ds_read_b128 v[44:47], v134
    ds_read_b64 v[124:125], v138
    ds_read_b64 v[126:127], v109 offset:2752
    ds_read_b32 v100, v109 offset:2760
    s_waitcnt lgkmcnt(5)
    v_max_f32_dpp v102, v101, v101 quad_perm:[1,0,3,2] row_mask:0xf bank_mask:0xf
    s_waitcnt lgkmcnt(4)
    v_add_f32 v52, v52, v53
    v_max_f32_dpp v102, v102, v102 quad_perm:[2,3,0,1] row_mask:0xf bank_mask:0xf
    v_add_f32 v54, v54, v55
    v_sub_f32 v101, v101, v102
    v_exp_f32 v101, v101
    v_add_f32 v52, v52, v54
    v_mul_f32 v52, v52, v101
    s_waitcnt lgkmcnt(3)
    v_mul_f32 v44, v44, v101
    v_add_f32_dpp v52, v52, v52 quad_perm:[1,0,3,2] row_mask:0xf bank_mask:0xf
    v_mul_f32 v45, v45, v101
    v_mul_f32 v46, v46, v101
    v_add_f32_dpp v52, v52, v52 quad_perm:[2,3,0,1] row_mask:0xf bank_mask:0xf
    v_mul_f32 v47, v47, v101
    v_log_f32 v53, v52
    v_rcp_f32 v52, v52
    v_add_f32_dpp v44, v44, v44 quad_perm:[1,0,3,2] row_mask:0xf bank_mask:0xf
    v_add_f32_dpp v45, v45, v45 quad_perm:[1,0,3,2] row_mask:0xf bank_mask:0xf
    v_add_f32_dpp v46, v46, v46 quad_perm:[1,0,3,2] row_mask:0xf bank_mask:0xf
    v_add_f32_dpp v47, v47, v47 quad_perm:[1,0,3,2] row_mask:0xf bank_mask:0xf
    v_add_f32 v53, v53, v102
    v_add_f32_dpp v44, v44, v44 quad_perm:[2,3,0,1] row_mask:0xf bank_mask:0xf
    v_add_f32_dpp v45, v45, v45 quad_perm:[2,3,0,1] row_mask:0xf bank_mask:0xf
    v_add_f32_dpp v46, v46, v46 quad_perm:[2,3,0,1] row_mask:0xf bank_mask:0xf
    v_add_f32_dpp v47, v47, v47 quad_perm:[2,3,0,1] row_mask:0xf bank_mask:0xf
    v_bfe_u32 v48, v53, 0, 8
    v_mul_f32 v44, v44, v52
    v_lshl_or_b32 v48, v48, 4, s76
    v_and_or_b32 v44, v44, s61, v48
    v_bfe_u32 v49, v53, 8, 8
    v_mul_f32 v45, v45, v52
    v_lshl_or_b32 v49, v49, 4, s77
    v_and_or_b32 v45, v45, s61, v49
    v_bfe_u32 v50, v53, 16, 8
    v_mul_f32 v46, v46, v52
    v_lshl_or_b32 v50, v50, 4, s78
    v_and_or_b32 v46, v46, s61, v50
    v_bfe_u32 v51, v53, 24, 8
    v_mul_f32 v47, v47, v52
    v_lshl_or_b32 v51, v51, 4, s79
    v_and_or_b32 v47, v47, s61, v51
    s_mov_b64 exec, 0x11111111
    buffer_store_dwordx4 v[44:47], v135, s[36:39], s60 offen sc1
    s_mov_b64 exec, -1
    s_waitcnt lgkmcnt(0)
    v_readfirstlane_b32 s56, v100
    v_and_b32 v72, v124, v4
    v_and_b32 v73, v124, v5
    v_and_b32 v74, v124, v6
    v_and_b32 v75, v124, v7
    v_and_b32 v76, v125, v4
    v_and_b32 v77, v125, v5
    v_and_b32 v78, v125, v6
    v_and_b32 v79, v125, v7
    s_mov_b32 s52, s57
    s_add_u32 s48, s52, s3
    s_and_b32 s48, s48, 31
    s_lshl_b32 s48, s48, 12
    v_lshl_add_u32 v128, v0, 4, s48
    s_lshr_b32 s48, s3, 1
    s_add_u32 s48, s48, s52
    s_add_u32 s48, s48, 4
    s_and_b32 s48, s48, 31
    s_lshl_b32 s48, s48, 1
    s_and_b32 s49, s3, 1
    s_add_u32 s48, s48, s49
    s_lshl_b32 s48, s48, 11
    v_lshl_add_u32 v129, v0, 4, s48
    s_add_u32 s50, s57, 6
    buffer_load_dwordx4 v[144:147], v136, s[36:39], s55 offen sc1
L_h1_wait:
    ds_read_b32 v110, v109
    ds_read_b128 v[112:115], v129 offset:0
    ds_read_b128 v[116:119], v129 offset:1024
    ds_read_b128 v[28:31], v128 offset:0
    ds_read_b128 v[32:35], v128 offset:1024
    ds_read_b128 v[36:39], v128 offset:2048
    ds_read_b128 v[40:43], v128 offset:3072
    s_sub_u32 s96, s96, 1
    s_cbranch_scc1 L_end
    s_waitcnt lgkmcnt(6)
    v_cmp_gt_u32 vcc, s50, v110
    s_cbranch_vccnz L_h1_wait
    s_branch L_h1_first
L_h1_poll:
    buffer_load_dwordx4 v[144:147], v136, s[36:39], s55 offen sc1
    s_sub_u32 s96, s96, 1
    s_cbranch_scc1 L_end
L_h1_first:
    s_waitcnt vmcnt(0)
    v_xor_b32 v52, s76, v144
    v_xor_b32 v53, s77, v145
    v_xor_b32 v54, s78, v146
    v_xor_b32 v55, s79, v147
    v_or3_b32 v68, v52, v53, v54
    v_or_b32 v68, v68, v55
    v_and_b32 v68, 15, v68
    v_cmp_ne_u32 vcc, 0, v68
    v_bfe_u32 v48, v52, 4, 8
    s_cbranch_vccnz L_h1_poll
    v_bfe_u32 v49, v53, 4, 8
    v_bfe_u32 v50, v54, 4, 8
    v_bfe_u32 v51, v55, 4, 8
    v_lshl_or_b32 v48, v49, 8, v48
    v_lshl_or_b32 v50, v51, 8, v50
    v_lshl_or_b32 v48, v50, 16, v48
    v_and_b32 v52, s61, v52
    v_and_b32 v53, s61, v53
    v_max_f32_dpp v101, v48, v48 quad_perm:[1,0,3,2] row_mask:0xf bank_mask:0xf
    v_and_b32 v54, s61, v54
    v_and_b32 v55, s61, v55
    v_max_f32_dpp v101, v101, v101 quad_perm:[2,3,0,1] row_mask:0xf bank_mask:0xf
    s_waitcnt lgkmcnt(0)
    v_mfma_f32_16x16x32_bf16 v[120:123], v[72:75], v[112:115], 0
    s_cmp_eq_u32 s3, 3
    v_max_f32_dpp v101, v101, v101 row_half_mirror row_mask:0xf bank_mask:0xf
    v_sub_f32 v101, v48, v101
    v_exp_f32 v101, v101
    s_cbranch_scc1 L_w2_one
    v_mfma_f32_16x16x32_bf16 v[120:123], v[76:79], v[116:119], v[120:123]
L_w2_one:
    v_mul_f32 v52, v52, v101
    v_mul_f32 v53, v53, v101
    v_mul_f32 v54, v54, v101
    v_mul_f32 v55, v55, v101
    v_add_f32_dpp v101, v101, v101 quad_perm:[1,0,3,2] row_mask:0xf bank_mask:0xf
    v_add_f32_dpp v52, v52, v52 quad_perm:[1,0,3,2] row_mask:0xf bank_mask:0xf
    v_add_f32_dpp v53, v53, v53 quad_perm:[1,0,3,2] row_mask:0xf bank_mask:0xf
    v_add_f32_dpp v54, v54, v54 quad_perm:[1,0,3,2] row_mask:0xf bank_mask:0xf
    v_add_f32_dpp v55, v55, v55 quad_perm:[1,0,3,2] row_mask:0xf bank_mask:0xf
    v_add_f32_dpp v101, v101, v101 quad_perm:[2,3,0,1] row_mask:0xf bank_mask:0xf
    v_add_f32_dpp v52, v52, v52 quad_perm:[2,3,0,1] row_mask:0xf bank_mask:0xf
    v_add_f32_dpp v53, v53, v53 quad_perm:[2,3,0,1] row_mask:0xf bank_mask:0xf
    v_add_f32_dpp v54, v54, v54 quad_perm:[2,3,0,1] row_mask:0xf bank_mask:0xf
    v_add_f32_dpp v55, v55, v55 quad_perm:[2,3,0,1] row_mask:0xf bank_mask:0xf
    v_add_f32_dpp v101, v101, v101 row_half_mirror row_mask:0xf bank_mask:0xf
    v_rcp_f32 v101, v101
    v_add_f32_dpp v52, v52, v52 row_half_mirror row_mask:0xf bank_mask:0xf
    v_add_f32_dpp v53, v53, v53 row_half_mirror row_mask:0xf bank_mask:0xf
    v_add_f32_dpp v54, v54, v54 row_half_mirror row_mask:0xf bank_mask:0xf
    v_add_f32_dpp v55, v55, v55 row_half_mirror row_mask:0xf bank_mask:0xf
    v_mul_f32 v52, v52, v101
    v_mul_f32 v53, v53, v101
    v_mul_f32 v54, v54, v101
    v_mul_f32 v55, v55, v101
    v_cvt_pk_bf16_f32 v52, v52, v52
    v_cvt_pk_bf16_f32 v53, v53, v53
    v_cvt_pk_bf16_f32 v54, v54, v54
    v_cvt_pk_bf16_f32 v55, v55, v55
    v_and_b32 v84, v52, v4
    v_and_b32 v85, v52, v5
    v_and_b32 v86, v52, v6
    v_and_b32 v87, v52, v7
    v_and_b32 v88, v53, v4
    v_and_b32 v89, v53, v5
    v_and_b32 v90, v53, v6
    v_and_b32 v91, v53, v7
    v_mfma_f32_16x16x32_bf16 v[44:47], v[84:87], v[28:31], 0
    v_and_b32 v92, v54, v4
    v_and_b32 v93, v54, v5
    v_and_b32 v94, v54, v6
    v_and_b32 v95, v54, v7
    v_mfma_f32_16x16x32_bf16 v[44:47], v[88:91], v[32:35], v[44:47]
    v_and_b32 v96, v55, v4
    v_and_b32 v97, v55, v5
    v_and_b32 v98, v55, v6
    v_and_b32 v99, v55, v7
    v_mfma_f32_16x16x32_bf16 v[44:47], v[92:95], v[36:39], v[44:47]
    v_mul_f32 v120, v120, v127
    v_mfma_f32_16x16x32_bf16 v[44:47], v[96:99], v[40:43], v[44:47]
    v_mul_f32 v121, v121, v127
    v_mul_f32 v122, v122, v127
    v_mul_f32 v123, v123, v127
    s_and_b32 s48, s4, 7
    s_cmp_eq_u32 s56, 0
    s_nop 2
    v_fma_f32 v44, v44, v126, v120
    v_fma_f32 v45, v45, v126, v121
    v_fma_f32 v46, v46, v126, v122
    v_fma_f32 v47, v47, v126, v123
    v_permlane32_swap_b32 v44, v48
    v_permlane32_swap_b32 v45, v49
    v_permlane32_swap_b32 v46, v50
    v_permlane32_swap_b32 v47, v51
    v_add_f32_dpp v44, v48, v44 row_ror:8 row_mask:0xf bank_mask:0xf
    v_add_f32_dpp v45, v49, v45 row_ror:8 row_mask:0xf bank_mask:0xf
    v_add_f32_dpp v46, v50, v46 row_ror:8 row_mask:0xf bank_mask:0xf
    v_add_f32_dpp v47, v51, v47 row_ror:8 row_mask:0xf bank_mask:0xf
    v_bfi_b32 v44, v8, s44, v44
    v_bfi_b32 v45, v8, s45, v45
    v_bfi_b32 v46, v8, s46, v46
    v_bfi_b32 v47, v8, s47, v47
    s_mov_b64 exec, 0xff00ff
    s_cbranch_scc1 L_z_far
    buffer_store_dwordx4 v[44:47], v137, s[36:39], s62 offen
L_z_back:
    s_mov_b64 exec, -1
    s_cmp_lg_u32 s48, s5
    s_cbranch_scc1 L_fin
    buffer_load_dwordx4 v[160:163], v139, s[36:39], s68 offen offset:0 sc1
    buffer_load_dwordx4 v[164:167], v139, s[36:39], s68 offen offset:2048 sc1
L_h2_poll:
    buffer_load_dwordx4 v[168:171], v139, s[36:39], s68 offen offset:0 sc1
    buffer_load_dwordx4 v[172:175], v139, s[36:39], s68 offen offset:2048 sc1
    s_sub_u32 s96, s96, 1
    s_cbranch_scc1 L_end
    s_waitcnt vmcnt(2)
    v_xor_b32 v52, s44, v160
    v_xor_b32 v53, s45, v161
    v_xor_b32 v54, s46, v162
    v_xor_b32 v55, s47, v163
    v_xor_b32 v56, s44, v164
    v_xor_b32 v57, s45, v165
    v_xor_b32 v58, s46, v166
    v_xor_b32 v59, s47, v167
    v_or3_b32 v48, v52, v53, v54
    v_or3_b32 v48, v48, v55, v56
    v_or3_b32 v48, v48, v57, v58
    v_or_b32 v48, v48, v59
    v_and_b32 v48, 1023, v48
    v_cmp_ne_u32 vcc, 0, v48
    s_cbranch_vccz L_h2_ok
    buffer_load_dwordx4 v[160:163], v139, s[36:39], s68 offen offset:0 sc1
    buffer_load_dwordx4 v[164:167], v139, s[36:39], s68 offen offset:2048 sc1
    s_waitcnt vmcnt(2)
    v_xor_b32 v52, s44, v168
    v_xor_b32 v53, s45, v169
    v_xor_b32 v54, s46, v170
    v_xor_b32 v55, s47, v171
    v_xor_b32 v56, s44, v172
    v_xor_b32 v57, s45, v173
    v_xor_b32 v58, s46, v174
    v_xor_b32 v59, s47, v175
    v_or3_b32 v48, v52, v53, v54
    v_or3_b32 v48, v48, v55, v56
    v_or3_b32 v48, v48, v57, v58
    v_or_b32 v48, v48, v59
    v_and_b32 v48, 1023, v48
    v_cmp_ne_u32 vcc, 0, v48
    s_cbranch_vccnz L_h2_poll
L_h2_ok:
    v_add_f32 v52, v52, v56
    v_add_f32 v53, v53, v57
    v_add_f32 v54, v54, v58
    v_add_f32 v55, v55, v59
    v_permlane32_swap_b32 v52, v53
    s_nop 0
    v_permlane32_swap_b32 v54, v55
    v_add_f32 v52, v52, v53
    v_add_f32 v54, v54, v55
    s_nop 1
    v_permlane16_swap_b32 v52, v54
    v_add_f32 v52, v52, v54
    s_nop 1
    v_add_f32_dpp v52, v52, v52 quad_perm:[1,0,3,2] row_mask:0xf bank_mask:0xf
    s_nop 1
    v_add_f32_dpp v52, v52, v52 quad_perm:[2,3,0,1] row_mask:0xf bank_mask:0xf
    s_nop 1
    v_add_f32_dpp v52, v52, v52 row_half_mirror row_mask:0xf bank_mask:0xf
    s_nop 1
    v_add_f32_dpp v52, v52, v52 row_mirror row_mask:0xf bank_mask:0xf
    v_cvt_pk_bf16_f32 v52, v52, v52
    s_mov_b64 exec, s[74:75]
    buffer_store_short v52, v140, s[64:67], s69 offen
    s_or_b32 s48, s2, s3
    s_cmp_lg_u32 s48, 0
    s_cbranch_scc1 L_fin
    s_mov_b64 exec, 1
    v_mov_b32 v110, s7
    buffer_store_dword v110, off, s[36:39], 0
L_fin:
    s_endpgm
L_z_far:
    buffer_store_dwordx4 v[44:47], v137, s[36:39], s62 offen sc1
    s_branch L_z_back
L_newmax:
    s_nop 1
    v_max_f32_dpp v110, v110, v110 row_bcast:15 row_mask:0xa bank_mask:0xf
    s_nop 1
    v_max_f32_dpp v110, v110, v110 row_bcast:31 row_mask:0xc bank_mask:0xf
    s_nop 0
    v_readlane_b32 s48, v110, 63
    s_nop 1
    v_mov_b32 v101, s48
    v_mul_f32 v110, v101, v103
    v_sub_f32 v111, v102, v110
    v_exp_f32 v111, v111
    v_mov_b32 v102, v110
    v_mul_f32 v100, v100, v111
    v_mul_f32 v44, v44, v111
    v_mul_f32 v45, v45, v111
    v_mul_f32 v46, v46, v111
    v_mul_f32 v47, v47, v111
    s_branch L_c_back
L_bal:
    s_waitcnt lgkmcnt(0)
    s_load_dword s7, s[32:33], 0
    s_barrier
    s_mov_b32 s36, s32
    s_and_b32 s37, s33, 0xffff
    s_mov_b32 s38, 2097152
    s_mov_b32 s39, 0x20000
    v_mov_b32 v4, 131072
    v_lshlrev_b32 v5, 2, v0
    v_lshlrev_b32 v11, 7, v0
    s_lshl_b32 s48, s5, 14
    s_add_u32 s48, s48, 786432
    s_lshl_b32 s49, s4, 2
    s_add_u32 s49, s49, s48
    s_mov_b32 s51, 64
    s_mov_b32 s55, 1
    s_mov_b32 s61, 0
    s_waitcnt lgkmcnt(0)
    s_add_u32 s7, s7, 0x11111111
    v_mov_b32 v7, s7
    s_mov_b64 exec, 1
    buffer_load_dword v9, v11, s[36:39], s48 offen sc1
    s_mov_b64 exec, 1
L_b_cycle:
L_b_wait:
    ds_read_b32 v6, v4 offset:0
    s_sub_u32 s96, s96, 1
    s_cbranch_scc1 L_end
    s_waitcnt lgkmcnt(0)
    v_readfirstlane_b32 s35, v6
    s_nop 0
    s_cmp_lt_u32 s35, s51
    s_cbranch_scc1 L_b_wait
    buffer_store_dword v7, off, s[36:39], s49
    s_mov_b32 exec_lo, -1
    s_mov_b32 exec_hi, 0
    buffer_load_dword v8, v5, s[36:39], s48 offen
    s_mov_b32 s59, s48
    s_add_u32 s48, s48, 128
    s_waitcnt vmcnt(0)
    v_cmp_eq_u32 vcc, s7, v8
    s_nop 0
    s_bcnt1_i32_b32 s53, vcc_lo
    s_cmp_ge_u32 s53, 29
    s_cselect_b32 s52, 2, -1
    s_cmp_le_u32 s53, 22
    s_cselect_b32 s52, -16, s52
    s_add_i32 s61, s61, s52
    s_max_i32 s61, s61, 0
    s_min_i32 s61, s61, 5
    s_sub_i32 s55, s61, 1
    s_max_i32 s55, s55, 1
    s_lshl_b32 s53, s53, 1
    s_sub_i32 s53, s53, 33
    s_cmp_gt_i32 s53, 0
    s_cselect_b32 s54, 1, -1
    s_add_i32 s54, s54, s55
    s_min_i32 s54, s54, 4
    s_abs_i32 s53, s53
    s_cmp_lt_u32 s54, 2
    s_cselect_b32 s35, 1, 0
    s_xor_b32 s35, s35, s54
    v_mov_b32 v10, s35
    ds_write_b32 v4, v10 offset:12
    s_mov_b64 exec, 1
    buffer_load_dword v9, v11, s[36:39], s48 offen sc1
    s_mov_b64 exec, 1
    s_mov_b32 s58, s53
    s_mul_i32 s53, s53, 288
    s_lshr_b32 s53, s53, 8
    s_add_u32 s53, s53, 5
    s_min_u32 s53, s53, 47
    s_add_u32 s53, s53, s51
    s_min_u32 s53, s53, 496
L_b_part:
    ds_read_b32 v6, v4 offset:0
    s_sub_u32 s96, s96, 1
    s_cbranch_scc1 L_end
    s_waitcnt lgkmcnt(0)
    v_readfirstlane_b32 s35, v6
    s_nop 0
    s_cmp_lt_u32 s35, s53
    s_cbranch_scc1 L_b_part
    s_cmp_lt_u32 s55, 2
    s_cselect_b32 s35, 1, 0
    s_xor_b32 s35, s35, s55
    v_mov_b32 v10, s35
    ds_write_b32 v4, v10 offset:12
L_b_y3:
    s_add_u32 s49, s49, 128
    s_add_u32 s51, s51, 48
    s_cmp_lt_u32 s51, 488
    s_cbranch_scc1 L_b_cycle
    s_endpgm
L_aux:
    v_and_b32 v9, 7, v0
    v_mul_u32_u24 v82, 28672, v3
    v_lshl_add_u32 v82, v9, 4, v82
    v_cmp_eq_u32 vcc, 7, v9
    v_mov_b32 v83, 1835008
    s_nop 0
    v_cndmask_b32 v82, v82, v83, vcc
    s_mul_i32 s97, s5, 229376
    s_mul_i32 s35, s4, 112
    s_add_u32 s97, s97, s35
    s_lshl_b32 s98, s5, 7
    s_add_u32 s99, s98, 64
    s_mov_b32 s42, 1835008
    s_mov_b32 s43, 0x20000
    s_mov_b32 s46, 1835008
    s_mov_b32 s47, 0x20000
    s_waitcnt lgkmcnt(0)
    s_mov_b32 s40, s20
    s_and_b32 s41, s21, 0xffff
    s_mov_b32 s44, s22
    s_and_b32 s45, s23, 0xffff
    s_load_dwordx16 s[48:63], s[8:9], s98
    s_load_dwordx16 s[64:79], s[8:9], s99
    s_load_dword s7, s[32:33], 0
    buffer_load_dwordx4 v[96:99], v82, s[40:43], s97 offen nt
    buffer_load_dwordx4 v[128:131], v82, s[44:47], s97 offen nt
    s_add_u32 s97, s97, 3584
    buffer_load_dwordx4 v[100:103], v82, s[40:43], s97 offen nt
    buffer_load_dwordx4 v[132:135], v82, s[44:47], s97 offen nt
    s_add_u32 s97, s97, 3584
    buffer_load_dwordx4 v[104:107], v82, s[40:43], s97 offen nt
    buffer_load_dwordx4 v[136:139], v82, s[44:47], s97 offen nt
    s_add_u32 s97, s97, 3584
    buffer_load_dwordx4 v[108:111], v82, s[40:43], s97 offen nt
    buffer_load_dwordx4 v[140:143], v82, s[44:47], s97 offen nt
    s_add_u32 s97, s97, 3584
    buffer_load_dwordx4 v[112:115], v82, s[40:43], s97 offen nt
    buffer_load_dwordx4 v[144:147], v82, s[44:47], s97 offen nt
    s_add_u32 s97, s97, 3584
    buffer_load_dwordx4 v[116:119], v82, s[40:43], s97 offen nt
    buffer_load_dwordx4 v[148:151], v82, s[44:47], s97 offen nt
    s_add_u32 s97, s97, 3584
    buffer_load_dwordx4 v[120:123], v82, s[40:43], s97 offen nt
    buffer_load_dwordx4 v[152:155], v82, s[44:47], s97 offen nt
    s_add_u32 s97, s97, 3584
    buffer_load_dwordx4 v[124:127], v82, s[40:43], s97 offen nt
    buffer_load_dwordx4 v[156:159], v82, s[44:47], s97 offen nt
    s_barrier
    v_and_b32 v80, 1, v0
    v_lshlrev_b32 v80, 4, v80
    v_mov_b32 v81, 0xffff
    v_lshlrev_b32 v80, v80, v81
    v_bfe_u32 v81, v0, 1, 2
    v_cmp_eq_u32 vcc, 0, v81
    s_nop 1
    v_cndmask_b32 v4, 0, v80, vcc
    v_cmp_eq_u32 vcc, 1, v81
    s_nop 1
    v_cndmask_b32 v5, 0, v80, vcc
    v_cmp_eq_u32 vcc, 2, v81
    s_nop 1
    v_cndmask_b32 v6, 0, v80, vcc
    v_cmp_eq_u32 vcc, 3, v81
    s_nop 1
    v_cndmask_b32 v7, 0, v80, vcc
    v_mov_b32 v56, 131072
    s_mov_b32 s36, s32
    s_and_b32 s37, s33, 0xffff
    s_mov_b32 s38, 2097152
    s_mov_b32 s39, 0x20000
    s_waitcnt lgkmcnt(0)
    s_mov_b32 exec_lo, 255
    s_mov_b32 exec_hi, 0
    v_mov_b32 v12, s48
    v_mov_b32 v13, s49
    v_mov_b32 v14, s50
    v_mov_b32 v15, s51
    s_mov_b32 exec_lo, 65280
    s_mov_b32 exec_hi, 0
    v_mov_b32 v12, s52
    v_mov_b32 v13, s53
    v_mov_b32 v14, s54
    v_mov_b32 v15, s55
    s_mov_b32 exec_lo, 16711680
    s_mov_b32 exec_hi, 0
    v_mov_b32 v12, s56
    v_mov_b32 v13, s57
    v_mov_b32 v14, s58
    v_mov_b32 v15, s59
    s_mov_b32 exec_lo, 4278190080
    s_mov_b32 exec_hi, 0
    v_mov_b32 v12, s60
    v_mov_b32 v13, s61
    v_mov_b32 v14, s62
    v_mov_b32 v15, s63
    s_mov_b32 exec_lo, 0
    s_mov_b32 exec_hi, 255
    v_mov_b32 v12, s64
    v_mov_b32 v13, s65
    v_mov_b32 v14, s66
    v_mov_b32 v15, s67
    s_mov_b32 exec_lo, 0
    s_mov_b32 exec_hi, 65280
    v_mov_b32 v12, s68
    v_mov_b32 v13, s69
    v_mov_b32 v14, s70
    v_mov_b32 v15, s71
    s_mov_b32 exec_lo, 0
    s_mov_b32 exec_hi, 16711680
    v_mov_b32 v12, s72
    v_mov_b32 v13, s73
    v_mov_b32 v14, s74
    v_mov_b32 v15, s75
    s_mov_b32 exec_lo, 0
    s_mov_b32 exec_hi, 4278190080
    v_mov_b32 v12, s76
    v_mov_b32 v13, s77
    v_mov_b32 v14, s78
    v_mov_b32 v15, s79
    s_mov_b64 exec, -1
    s_load_dwordx16 s[48:63], s[26:27], s98
    s_load_dwordx16 s[64:79], s[26:27], s99
    s_add_u32 s7, s7, 0x11111111
    s_getreg_b32 s97, hwreg(HW_REG_XCC_ID, 0, 4)
    s_lshl_b32 s97, s97, 28
    s_and_b32 s35, s7, 0xfffffff
    s_or_b32 s97, s97, s35
    s_and_b32 s35, s4, 7
    s_cmp_lg_u32 s35, s5
    s_cbranch_scc1 L_noxid
    s_lshl_b32 s35, s5, 7
    s_and_b32 s40, s4, 24
    s_add_u32 s35, s35, s40
    s_add_u32 s35, s35, 4096
    v_mov_b32 v58, s97
    v_mov_b32 v59, s7
    s_mov_b64 exec, 1
    buffer_store_dwordx2 v[58:59], off, s[36:39], s35 sc1
    s_mov_b64 exec, -1
L_noxid:
    s_mov_b32 s100, 0x01000100
    s_mov_b32 s101, 0x03020302
    v_perm_b32 v80, v12, v12, s100
    v_and_b32 v36, v80, v4
    v_and_b32 v37, v80, v5
    v_and_b32 v38, v80, v6
    v_and_b32 v39, v80, v7
    s_waitcnt vmcnt(14)
    s_nop 0
    v_mfma_f32_16x16x32_bf16 v[24:27], v[36:39], v[96:99], 0
    v_mfma_f32_16x16x32_bf16 v[28:31], v[36:39], v[128:131], 0
    v_perm_b32 v80, v12, v12, s101
    v_and_b32 v40, v80, v4
    v_and_b32 v41, v80, v5
    v_and_b32 v42, v80, v6
    v_and_b32 v43, v80, v7
    s_waitcnt vmcnt(12)
    s_nop 0
    v_mfma_f32_16x16x32_bf16 v[24:27], v[40:43], v[100:103], v[24:27]
    v_mfma_f32_16x16x32_bf16 v[28:31], v[40:43], v[132:135], v[28:31]
    v_perm_b32 v80, v13, v13, s100
    v_and_b32 v44, v80, v4
    v_and_b32 v45, v80, v5
    v_and_b32 v46, v80, v6
    v_and_b32 v47, v80, v7
    s_waitcnt vmcnt(10)
    s_nop 0
    v_mfma_f32_16x16x32_bf16 v[24:27], v[44:47], v[104:107], v[24:27]
    v_mfma_f32_16x16x32_bf16 v[28:31], v[44:47], v[136:139], v[28:31]
    v_perm_b32 v80, v13, v13, s101
    v_and_b32 v48, v80, v4
    v_and_b32 v49, v80, v5
    v_and_b32 v50, v80, v6
    v_and_b32 v51, v80, v7
    s_waitcnt vmcnt(8)
    s_nop 0
    v_mfma_f32_16x16x32_bf16 v[24:27], v[48:51], v[108:111], v[24:27]
    v_mfma_f32_16x16x32_bf16 v[28:31], v[48:51], v[140:143], v[28:31]
    v_perm_b32 v80, v14, v14, s100
    v_and_b32 v36, v80, v4
    v_and_b32 v37, v80, v5
    v_and_b32 v38, v80, v6
    v_and_b32 v39, v80, v7
    s_waitcnt vmcnt(6)
    s_nop 0
    v_mfma_f32_16x16x32_bf16 v[24:27], v[36:39], v[112:115], v[24:27]
    v_mfma_f32_16x16x32_bf16 v[28:31], v[36:39], v[144:147], v[28:31]
    v_perm_b32 v80, v14, v14, s101
    v_and_b32 v40, v80, v4
    v_and_b32 v41, v80, v5
    v_and_b32 v42, v80, v6
    v_and_b32 v43, v80, v7
    s_waitcnt vmcnt(4)
    s_nop 0
    v_mfma_f32_16x16x32_bf16 v[24:27], v[40:43], v[116:119], v[24:27]
    v_mfma_f32_16x16x32_bf16 v[28:31], v[40:43], v[148:151], v[28:31]
    v_perm_b32 v80, v15, v15, s100
    v_and_b32 v44, v80, v4
    v_and_b32 v45, v80, v5
    v_and_b32 v46, v80, v6
    v_and_b32 v47, v80, v7
    s_waitcnt vmcnt(2)
    s_nop 0
    v_mfma_f32_16x16x32_bf16 v[24:27], v[44:47], v[120:123], v[24:27]
    v_mfma_f32_16x16x32_bf16 v[28:31], v[44:47], v[152:155], v[28:31]
    v_perm_b32 v80, v15, v15, s101
    v_and_b32 v48, v80, v4
    v_and_b32 v49, v80, v5
    v_and_b32 v50, v80, v6
    v_and_b32 v51, v80, v7
    s_waitcnt vmcnt(0)
    s_nop 0
    v_mfma_f32_16x16x32_bf16 v[24:27], v[48:51], v[124:127], v[24:27]
    v_mfma_f32_16x16x32_bf16 v[28:31], v[48:51], v[156:159], v[28:31]
    s_waitcnt lgkmcnt(0)
    s_mov_b32 exec_lo, 255
    s_mov_b32 exec_hi, 0
    v_mov_b32 v16, s48
    v_mov_b32 v17, s49
    v_mov_b32 v18, s50
    v_mov_b32 v19, s51
    s_mov_b32 exec_lo, 65280
    s_mov_b32 exec_hi, 0
    v_mov_b32 v16, s52
    v_mov_b32 v17, s53
    v_mov_b32 v18, s54
    v_mov_b32 v19, s55
    s_mov_b32 exec_lo, 16711680
    s_mov_b32 exec_hi, 0
    v_mov_b32 v16, s56
    v_mov_b32 v17, s57
    v_mov_b32 v18, s58
    v_mov_b32 v19, s59
    s_mov_b32 exec_lo, 4278190080
    s_mov_b32 exec_hi, 0
    v_mov_b32 v16, s60
    v_mov_b32 v17, s61
    v_mov_b32 v18, s62
    v_mov_b32 v19, s63
    s_mov_b32 exec_lo, 0
    s_mov_b32 exec_hi, 255
    v_mov_b32 v16, s64
    v_mov_b32 v17, s65
    v_mov_b32 v18, s66
    v_mov_b32 v19, s67
    s_mov_b32 exec_lo, 0
    s_mov_b32 exec_hi, 65280
    v_mov_b32 v16, s68
    v_mov_b32 v17, s69
    v_mov_b32 v18, s70
    v_mov_b32 v19, s71
    s_mov_b32 exec_lo, 0
    s_mov_b32 exec_hi, 16711680
    v_mov_b32 v16, s72
    v_mov_b32 v17, s73
    v_mov_b32 v18, s74
    v_mov_b32 v19, s75
    s_mov_b32 exec_lo, 0
    s_mov_b32 exec_hi, 4278190080
    v_mov_b32 v16, s76
    v_mov_b32 v17, s77
    v_mov_b32 v18, s78
    v_mov_b32 v19, s79
    s_mov_b64 exec, -1
    v_mov_b32 v10, 0
    v_lshlrev_b32 v80, 16, v12
    v_lshlrev_b32 v81, 16, v16
    v_mul_f32 v80, v80, v81
    v_and_b32 v81, 0xffff0000, v12
    v_and_b32 v83, 0xffff0000, v16
    v_mul_f32 v81, v81, v83
    v_cvt_pk_bf16_f32 v80, v80, v81
    v_lshlrev_b32 v81, 16, v80
    v_and_b32 v80, 0xffff0000, v80
    v_add_f32 v10, v10, v80
    v_add_f32 v10, v10, v81
    v_lshlrev_b32 v80, 16, v13
    v_lshlrev_b32 v81, 16, v17
    v_mul_f32 v80, v80, v81
    v_and_b32 v81, 0xffff0000, v13
    v_and_b32 v83, 0xffff0000, v17
    v_mul_f32 v81, v81, v83
    v_cvt_pk_bf16_f32 v80, v80, v81
    v_lshlrev_b32 v81, 16, v80
    v_and_b32 v80, 0xffff0000, v80
    v_add_f32 v10, v10, v80
    v_add_f32 v10, v10, v81
    v_lshlrev_b32 v80, 16, v14
    v_lshlrev_b32 v81, 16, v18
    v_mul_f32 v80, v80, v81
    v_and_b32 v81, 0xffff0000, v14
    v_and_b32 v83, 0xffff0000, v18
    v_mul_f32 v81, v81, v83
    v_cvt_pk_bf16_f32 v80, v80, v81
    v_lshlrev_b32 v81, 16, v80
    v_and_b32 v80, 0xffff0000, v80
    v_add_f32 v10, v10, v80
    v_add_f32 v10, v10, v81
    v_lshlrev_b32 v80, 16, v15
    v_lshlrev_b32 v81, 16, v19
    v_mul_f32 v80, v80, v81
    v_and_b32 v81, 0xffff0000, v15
    v_and_b32 v83, 0xffff0000, v19
    v_mul_f32 v81, v81, v83
    v_cvt_pk_bf16_f32 v80, v80, v81
    v_lshlrev_b32 v81, 16, v80
    v_and_b32 v80, 0xffff0000, v80
    v_add_f32 v10, v10, v80
    v_add_f32 v10, v10, v81
    s_nop 1
    v_add_f32_dpp v10, v10, v10 row_ror:8 row_mask:0xf bank_mask:0xf
    s_nop 1
    v_add_f32_dpp v10, v10, v10 row_bcast:15 row_mask:0xa bank_mask:0xf
    s_nop 1
    v_add_f32_dpp v10, v10, v10 row_bcast:31 row_mask:0xc bank_mask:0xf
    s_nop 0
    v_readlane_b32 s50, v10, 63
    v_lshlrev_b32 v80, 5, v2
    v_lshl_add_u32 v80, v1, 4, v80
    s_lshl_b32 s48, s2, 9
    s_add_u32 s48, s48, 262144
    v_permlane32_swap_b32 v24, v32
    v_permlane32_swap_b32 v25, v33
    v_permlane32_swap_b32 v26, v34
    v_permlane32_swap_b32 v27, v35
    v_add_f32_dpp v24, v32, v24 row_ror:8 row_mask:0xf bank_mask:0xf
    v_add_f32_dpp v25, v33, v25 row_ror:8 row_mask:0xf bank_mask:0xf
    v_add_f32_dpp v26, v34, v26 row_ror:8 row_mask:0xf bank_mask:0xf
    v_add_f32_dpp v27, v35, v27 row_ror:8 row_mask:0xf bank_mask:0xf
    v_permlane32_swap_b32 v28, v32
    v_permlane32_swap_b32 v29, v33
    v_permlane32_swap_b32 v30, v34
    v_permlane32_swap_b32 v31, v35
    v_add_f32_dpp v28, v32, v28 row_ror:8 row_mask:0xf bank_mask:0xf
    v_add_f32_dpp v29, v33, v29 row_ror:8 row_mask:0xf bank_mask:0xf
    v_add_f32_dpp v30, v34, v30 row_ror:8 row_mask:0xf bank_mask:0xf
    v_add_f32_dpp v31, v35, v31 row_ror:8 row_mask:0xf bank_mask:0xf
    s_mov_b64 exec, 0x80
    v_mov_b32 v24, s50
    s_mov_b64 exec, -1
    s_bfe_u32 s76, s7, 262144
    s_bfe_u32 s77, s7, 262148
    s_bfe_u32 s78, s7, 262152
    s_bfe_u32 s79, s7, 262156
    v_bfi_b32 v24, 15, s76, v24
    v_bfi_b32 v25, 15, s77, v25
    v_bfi_b32 v26, 15, s78, v26
    v_bfi_b32 v27, 15, s79, v27
    v_bfi_b32 v28, 15, s76, v28
    v_bfi_b32 v29, 15, s77, v29
    v_bfi_b32 v30, 15, s78, v30
    v_bfi_b32 v31, 15, s79, v31
    s_mov_b64 exec, 0xff00ff
    buffer_store_dwordx4 v[24:27], v80, s[36:39], s48 offen sc1
    buffer_store_dwordx4 v[28:31], v80, s[36:39], s48 offen offset:256 sc1
    s_mov_b64 exec, -1
    s_add_u32 s49, s4, 4
    s_and_b32 s49, s49, 7
    s_cmp_lg_u32 s49, s5
    s_cbranch_scc1 L_h_follow
    v_lshlrev_b32 v82, 9, v9
    v_mul_u32_u24 v81, 28, v3
    v_add_u32 v80, v82, v81
    s_lshl_b32 s48, s4, 12
    s_add_u32 s48, s48, 262144
    s_add_u32 s49, s4, 48
    v_add_u32 v60, 0, v81
    v_and_b32 v60, 12, v60
    v_bfe_u32 v60, s7, v60, 4
    v_add_u32 v61, 4, v81
    v_and_b32 v61, 12, v61
    v_bfe_u32 v61, s7, v61, 4
    v_add_u32 v62, 8, v81
    v_and_b32 v62, 12, v62
    v_bfe_u32 v62, s7, v62, 4
    v_add_u32 v63, 12, v81
    v_and_b32 v63, 12, v63
    v_bfe_u32 v63, s7, v63, 4
L_f_wait:
    ds_read_b32 v57, v56 offset:0
    s_sub_u32 s96, s96, 1
    s_cbranch_scc1 L_end
    s_waitcnt lgkmcnt(0)
    v_readfirstlane_b32 s35, v57
    s_nop 0
    s_cmp_lt_u32 s35, s49
    s_cbranch_scc1 L_f_wait
L_f_poll:
    buffer_load_dwordx4 v[96:99], v80, s[36:39], s48 offen sc1
    buffer_load_dwordx3 v[100:102], v80, s[36:39], s48 offen offset:16 sc1
    buffer_load_dwordx4 v[104:107], v80, s[36:39], s48 offen offset:256 sc1
    buffer_load_dwordx3 v[108:110], v80, s[36:39], s48 offen offset:272 sc1
    buffer_load_dwordx4 v[112:115], v82, s[36:39], s48 offen offset:224 sc1
    s_sub_u32 s96, s96, 1
    s_cbranch_scc1 L_end
    s_waitcnt vmcnt(0)
    v_xor_b32 v96, v60, v96
    v_xor_b32 v97, v61, v97
    v_xor_b32 v98, v62, v98
    v_xor_b32 v99, v63, v99
    v_xor_b32 v100, v60, v100
    v_xor_b32 v101, v61, v101
    v_xor_b32 v102, v62, v102
    v_xor_b32 v104, v60, v104
    v_xor_b32 v105, v61, v105
    v_xor_b32 v106, v62, v106
    v_xor_b32 v107, v63, v107
    v_xor_b32 v108, v60, v108
    v_xor_b32 v109, v61, v109
    v_xor_b32 v110, v62, v110
    v_xor_b32 v112, s76, v112
    v_xor_b32 v113, s77, v113
    v_xor_b32 v114, s78, v114
    v_xor_b32 v115, s79, v115
    v_or3_b32 v81, v96, v97, v98
    v_or3_b32 v81, v81, v99, v100
    v_or3_b32 v81, v81, v101, v102
    v_or3_b32 v81, v81, v104, v105
    v_or3_b32 v81, v81, v106, v107
    v_or3_b32 v81, v81, v108, v109
    v_or3_b32 v81, v81, v110, v112
    v_or3_b32 v81, v81, v113, v114
    v_or_b32 v81, v81, v115
    v_and_b32 v81, 15, v81
    v_cmp_ne_u32 vcc, 0, v81
    s_cbranch_vccnz L_f_poll
    v_add_f32_dpp v96, v96, v96 quad_perm:[1,0,3,2] row_mask:0xf bank_mask:0xf
    v_add_f32_dpp v97, v97, v97 quad_perm:[1,0,3,2] row_mask:0xf bank_mask:0xf
    v_add_f32_dpp v98, v98, v98 quad_perm:[1,0,3,2] row_mask:0xf bank_mask:0xf
    v_add_f32_dpp v99, v99, v99 quad_perm:[1,0,3,2] row_mask:0xf bank_mask:0xf
    v_add_f32_dpp v100, v100, v100 quad_perm:[1,0,3,2] row_mask:0xf bank_mask:0xf
    v_add_f32_dpp v101, v101, v101 quad_perm:[1,0,3,2] row_mask:0xf bank_mask:0xf
    v_add_f32_dpp v102, v102, v102 quad_perm:[1,0,3,2] row_mask:0xf bank_mask:0xf
    v_add_f32_dpp v104, v104, v104 quad_perm:[1,0,3,2] row_mask:0xf bank_mask:0xf
    v_add_f32_dpp v105, v105, v105 quad_perm:[1,0,3,2] row_mask:0xf bank_mask:0xf
    v_add_f32_dpp v106, v106, v106 quad_perm:[1,0,3,2] row_mask:0xf bank_mask:0xf
    v_add_f32_dpp v107, v107, v107 quad_perm:[1,0,3,2] row_mask:0xf bank_mask:0xf
    v_add_f32_dpp v108, v108, v108 quad_perm:[1,0,3,2] row_mask:0xf bank_mask:0xf
    v_add_f32_dpp v109, v109, v109 quad_perm:[1,0,3,2] row_mask:0xf bank_mask:0xf
    v_add_f32_dpp v110, v110, v110 quad_perm:[1,0,3,2] row_mask:0xf bank_mask:0xf
    v_add_f32_dpp v112, v112, v112 quad_perm:[1,0,3,2] row_mask:0xf bank_mask:0xf
    v_add_f32_dpp v96, v96, v96 quad_perm:[2,3,0,1] row_mask:0xf bank_mask:0xf
    v_add_f32_dpp v97, v97, v97 quad_perm:[2,3,0,1] row_mask:0xf bank_mask:0xf
    v_add_f32_dpp v98, v98, v98 quad_perm:[2,3,0,1] row_mask:0xf bank_mask:0xf
    v_add_f32_dpp v99, v99, v99 quad_perm:[2,3,0,1] row_mask:0xf bank_mask:0xf
    v_add_f32_dpp v100, v100, v100 quad_perm:[2,3,0,1] row_mask:0xf bank_mask:0xf
    v_add_f32_dpp v101, v101, v101 quad_perm:[2,3,0,1] row_mask:0xf bank_mask:0xf
    v_add_f32_dpp v102, v102, v102 quad_perm:[2,3,0,1] row_mask:0xf bank_mask:0xf
    v_add_f32_dpp v104, v104, v104 quad_perm:[2,3,0,1] row_mask:0xf bank_mask:0xf
    v_add_f32_dpp v105, v105, v105 quad_perm:[2,3,0,1] row_mask:0xf bank_mask:0xf
    v_add_f32_dpp v106, v106, v106 quad_perm:[2,3,0,1] row_mask:0xf bank_mask:0xf
    v_add_f32_dpp v107, v107, v107 quad_perm:[2,3,0,1] row_mask:0xf bank_mask:0xf
    v_add_f32_dpp v108, v108, v108 quad_perm:[2,3,0,1] row_mask:0xf bank_mask:0xf
    v_add_f32_dpp v109, v109, v109 quad_perm:[2,3,0,1] row_mask:0xf bank_mask:0xf
    v_add_f32_dpp v110, v110, v110 quad_perm:[2,3,0,1] row_mask:0xf bank_mask:0xf
    v_add_f32_dpp v112, v112, v112 quad_perm:[2,3,0,1] row_mask:0xf bank_mask:0xf
    v_add_f32_dpp v96, v96, v96 row_half_mirror row_mask:0xf bank_mask:0xf
    v_add_f32_dpp v97, v97, v97 row_half_mirror row_mask:0xf bank_mask:0xf
    v_add_f32_dpp v98, v98, v98 row_half_mirror row_mask:0xf bank_mask:0xf
    v_add_f32_dpp v99, v99, v99 row_half_mirror row_mask:0xf bank_mask:0xf
    v_add_f32_dpp v100, v100, v100 row_half_mirror row_mask:0xf bank_mask:0xf
    v_add_f32_dpp v101, v101, v101 row_half_mirror row_mask:0xf bank_mask:0xf
    v_add_f32_dpp v102, v102, v102 row_half_mirror row_mask:0xf bank_mask:0xf
    v_add_f32_dpp v104, v104, v104 row_half_mirror row_mask:0xf bank_mask:0xf
    v_add_f32_dpp v105, v105, v105 row_half_mirror row_mask:0xf bank_mask:0xf
    v_add_f32_dpp v106, v106, v106 row_half_mirror row_mask:0xf bank_mask:0xf
    v_add_f32_dpp v107, v107, v107 row_half_mirror row_mask:0xf bank_mask:0xf
    v_add_f32_dpp v108, v108, v108 row_half_mirror row_mask:0xf bank_mask:0xf
    v_add_f32_dpp v109, v109, v109 row_half_mirror row_mask:0xf bank_mask:0xf
    v_add_f32_dpp v110, v110, v110 row_half_mirror row_mask:0xf bank_mask:0xf
    v_add_f32_dpp v112, v112, v112 row_half_mirror row_mask:0xf bank_mask:0xf
    v_cvt_pk_bf16_f32 v96, v96, v96
    v_and_b32 v96, 0xffff0000, v96
    v_cvt_pk_bf16_f32 v97, v97, v97
    v_and_b32 v97, 0xffff0000, v97
    v_cvt_pk_bf16_f32 v98, v98, v98
    v_and_b32 v98, 0xffff0000, v98
    v_cvt_pk_bf16_f32 v99, v99, v99
    v_and_b32 v99, 0xffff0000, v99
    v_cvt_pk_bf16_f32 v100, v100, v100
    v_and_b32 v100, 0xffff0000, v100
    v_cvt_pk_bf16_f32 v101, v101, v101
    v_and_b32 v101, 0xffff0000, v101
    v_cvt_pk_bf16_f32 v102, v102, v102
    v_and_b32 v102, 0xffff0000, v102
    v_cvt_pk_bf16_f32 v104, v104, v104
    v_and_b32 v104, 0xffff0000, v104
    v_cvt_pk_bf16_f32 v105, v105, v105
    v_and_b32 v105, 0xffff0000, v105
    v_cvt_pk_bf16_f32 v106, v106, v106
    v_and_b32 v106, 0xffff0000, v106
    v_cvt_pk_bf16_f32 v107, v107, v107
    v_and_b32 v107, 0xffff0000, v107
    v_cvt_pk_bf16_f32 v108, v108, v108
    v_and_b32 v108, 0xffff0000, v108
    v_cvt_pk_bf16_f32 v109, v109, v109
    v_and_b32 v109, 0xffff0000, v109
    v_cvt_pk_bf16_f32 v110, v110, v110
    v_and_b32 v110, 0xffff0000, v110
    v_cvt_pk_bf16_f32 v112, v112, v112
    v_and_b32 v112, 0xffff0000, v112
    v_mul_f32 v10, 3216550459, v112
    v_exp_f32 v10, v10
    s_nop 0
    v_add_f32 v10, 1.0, v10
    v_rcp_f32 v10, v10
    s_nop 0
    v_cvt_pk_bf16_f32 v10, v10, v10
    v_and_b32 v10, 0xffff0000, v10
    v_sub_f32 v11, 1.0, v10
    v_cvt_pk_bf16_f32 v11, v11, v11
    v_and_b32 v11, 0xffff0000, v11
    v_mul_f32 v128, 3216550459, v96
    v_mul_f32 v129, 3216550459, v97
    v_mul_f32 v130, 3216550459, v98
    v_mul_f32 v131, 3216550459, v99
    v_mul_f32 v132, 3216550459, v100
    v_mul_f32 v133, 3216550459, v101
    v_mul_f32 v134, 3216550459, v102
    v_exp_f32 v128, v128
    v_exp_f32 v129, v129
    v_exp_f32 v130, v130
    v_exp_f32 v131, v131
    v_exp_f32 v132, v132
    v_exp_f32 v133, v133
    v_exp_f32 v134, v134
    v_add_f32 v128, 1.0, v128
    v_add_f32 v129, 1.0, v129
    v_add_f32 v130, 1.0, v130
    v_add_f32 v131, 1.0, v131
    v_add_f32 v132, 1.0, v132
    v_add_f32 v133, 1.0, v133
    v_add_f32 v134, 1.0, v134
    v_rcp_f32 v128, v128
    v_rcp_f32 v129, v129
    v_rcp_f32 v130, v130
    v_rcp_f32 v131, v131
    v_rcp_f32 v132, v132
    v_rcp_f32 v133, v133
    v_rcp_f32 v134, v134
    v_mul_f32 v128, v128, v96
    v_mul_f32 v129, v129, v97
    v_mul_f32 v130, v130, v98
    v_mul_f32 v131, v131, v99
    v_mul_f32 v132, v132, v100
    v_mul_f32 v133, v133, v101
    v_mul_f32 v134, v134, v102
    v_cvt_pk_bf16_f32 v128, v128, v128
    v_and_b32 v128, 0xffff0000, v128
    v_cvt_pk_bf16_f32 v129, v129, v129
    v_and_b32 v129, 0xffff0000, v129
    v_cvt_pk_bf16_f32 v130, v130, v130
    v_and_b32 v130, 0xffff0000, v130
    v_cvt_pk_bf16_f32 v131, v131, v131
    v_and_b32 v131, 0xffff0000, v131
    v_cvt_pk_bf16_f32 v132, v132, v132
    v_and_b32 v132, 0xffff0000, v132
    v_cvt_pk_bf16_f32 v133, v133, v133
    v_and_b32 v133, 0xffff0000, v133
    v_cvt_pk_bf16_f32 v134, v134, v134
    v_and_b32 v134, 0xffff0000, v134
    v_mul_f32 v128, v128, v104
    v_mul_f32 v129, v129, v105
    v_mul_f32 v130, v130, v106
    v_mul_f32 v131, v131, v107
    v_mul_f32 v132, v132, v108
    v_mul_f32 v133, v133, v109
    v_mul_f32 v134, v134, v110
    v_cvt_pk_bf16_f32 v128, v128, v128
    v_cvt_pk_bf16_f32 v129, v129, v129
    v_cvt_pk_bf16_f32 v130, v130, v130
    v_cvt_pk_bf16_f32 v131, v131, v131
    v_cvt_pk_bf16_f32 v132, v132, v132
    v_cvt_pk_bf16_f32 v133, v133, v133
    v_cvt_pk_bf16_f32 v134, v134, v134
    v_cmp_eq_u32 vcc, 0, v3
    s_nop 1
    v_cndmask_b32 v135, v11, v10, vcc
    v_cmp_eq_u32 vcc, 1, v9
    s_nop 1
    v_cndmask_b32 v128, v128, v132, vcc
    v_cndmask_b32 v129, v129, v133, vcc
    v_cndmask_b32 v130, v130, v134, vcc
    v_cndmask_b32 v131, v131, v135, vcc
    s_and_b32 s6, s7, 65535
    v_mov_b32 v8, s6
    s_mov_b32 s34, 4294901760
    v_and_or_b32 v128, v128, s34, v8
    v_and_or_b32 v129, v129, s34, v8
    v_and_or_b32 v130, v130, s34, v8
    v_and_or_b32 v131, v131, s34, v8
    v_lshlrev_b32 v80, 5, v3
    v_lshl_add_u32 v80, v9, 4, v80
    s_lshl_b32 s48, s4, 8
    s_add_u32 s48, s48, 32768
    s_mov_b32 exec_lo, 0x03030303
    s_mov_b32 exec_hi, 0x03030303
    buffer_store_dwordx4 v[128:131], v80, s[36:39], s48 offen sc1
    s_mov_b64 exec, -1
L_h_follow:
    s_lshl_b32 s49, s5, 2
    s_add_u32 s49, s49, s4
    s_add_u32 s49, s49, 160
L_h_wait:
    ds_read_b32 v57, v56 offset:0
    s_sub_u32 s96, s96, 1
    s_cbranch_scc1 L_end
    s_waitcnt lgkmcnt(0)
    v_readfirstlane_b32 s35, v57
    s_nop 0
    s_cmp_lt_u32 s35, s49
    s_cbranch_scc1 L_h_wait
    v_lshlrev_b32 v80, 2, v0
    s_lshl_b32 s48, s4, 8
    s_add_u32 s48, s48, 32768
    s_and_b32 s6, s7, 0xffff
L_h_poll:
    buffer_load_dword v128, v80, s[36:39], s48 offen sc1
    s_sub_u32 s96, s96, 1
    s_cbranch_scc1 L_end
    s_waitcnt vmcnt(0)
    v_xor_b32 v128, s6, v128
    v_and_b32 v81, 0xffff, v128
    v_cmp_ne_u32 vcc, 0, v81
    s_cbranch_vccnz L_h_poll
    v_readlane_b32 s48, v128, 7
    v_readlane_b32 s49, v128, 15
    v_perm_b32 v128, v128, v128, s101
    v_add_u32 v80, 133568, v80
    v_mov_b32 v10, s48
    v_mov_b32 v11, s49
    ds_write_b32 v80, v128
    ds_write_b64 v56, v[10:11] offset:2752
    s_lshl_b32 s35, s5, 7
    s_add_u32 s35, s35, 4096
L_x_poll:
    s_load_dwordx8 s[48:55], s[32:33], s35 glc
    s_sub_u32 s96, s96, 1
    s_cbranch_scc1 L_end
    s_waitcnt lgkmcnt(0)
    s_xor_b32 s48, s48, s97
    s_xor_b32 s49, s49, s7
    s_xor_b32 s50, s50, s97
    s_xor_b32 s51, s51, s7
    s_xor_b32 s52, s52, s97
    s_xor_b32 s53, s53, s7
    s_xor_b32 s54, s54, s97
    s_xor_b32 s55, s55, s7
    s_or_b64 s[48:49], s[48:49], s[50:51]
    s_or_b64 s[52:53], s[52:53], s[54:55]
    s_or_b64 s[48:49], s[48:49], s[52:53]
    s_and_b32 s50, s48, 0xfffffff
    s_or_b32 s50, s50, s49
    s_cbranch_scc1 L_x_poll
    s_cmp_eq_u32 s48, 0
    s_cselect_b32 s48, 1, 0
    v_mov_b32 v80, s48
    ds_write_b32 v56, v80 offset:2760
    s_waitcnt lgkmcnt(0)
L_end:
    s_endpgm
.section .rodata,"a"
.p2align 6
.amdhsa_kernel gated_mix__mha_block_cached__glu_gated_swiglu__decode_kernel
  .amdhsa_next_free_vgpr 192
  .amdhsa_next_free_sgpr 102
  .amdhsa_accum_offset 192
  .amdhsa_group_segment_fixed_size 0
  .amdhsa_kernarg_size 104
  .amdhsa_user_sgpr_count 2
  .amdhsa_user_sgpr_kernarg_segment_ptr 1
  .amdhsa_system_sgpr_workgroup_id_x 1
  .amdhsa_float_denorm_mode_32 3
.end_amdhsa_kernel
```
